```python
import torch

def _softmax(x, axis=-1):
    return torch.softmax(x, dim=axis)
def _gelu(x):
    return torch.nn.functional.gelu(x, approximate="tanh")
def _silu(x):
    return torch.nn.functional.silu(x)
def _sigmoid(x):
    return torch.sigmoid(x)
def _layernorm(x, axis=-1, eps=1e-5):
    m = x.mean(dim=axis, keepdim=True)
    v = x.var(dim=axis, keepdim=True, unbiased=False)
    return (x - m) / torch.sqrt(v + eps)
def _scatter_add(tgt, idx, src, axis=0):
    return tgt.clone().index_add_(axis, idx, src)
def _segment_sum(src, seg, n):
    out = torch.zeros((n,) + src.shape[1:], dtype=src.dtype)
    return out.index_add_(0, seg, src)
def _pad(x, pw):
    flat = tuple(v for pair in reversed(pw) for v in pair)
    return torch.nn.functional.pad(x, flat)

kernel_name = 'gated_mix__compressed_kv_cla__dense_activation_silu__decode'

def setup_inputs():

    _w = (lambda a: (lambda t: t.to(torch.bfloat16) if t.is_floating_point() else t)(torch.as_tensor(a)))
    def _A_setup():
        B, H, Sq, Sk, D, M = 1, 32, 1, 8192, 128, 512
        Dc = 4 * D
        return {
            "x": _w((lambda *s: torch.randn(*s, dtype=torch.bfloat16) * 0.05)(B, Sq, M)),
            "c_kv": _w((lambda *s: torch.randn(*s, dtype=torch.bfloat16) * 0.8)(B, Sk, Dc)),
            "w_q": _w((lambda *s: torch.randn(*s, dtype=torch.bfloat16) * 6.4)(M, H, D) * (M ** -0.5)),
            "w_uk": _w((lambda *s: torch.randn(*s, dtype=torch.bfloat16) * 6.4)(Dc, H, D) * (Dc ** -0.5)),
            "w_uv": _w((lambda *s: torch.randn(*s, dtype=torch.bfloat16) * 0.8)(Dc, H, D) * (Dc ** -0.5)),
            "w_o": _w((lambda *s: torch.randn(*s, dtype=torch.bfloat16) * 0.8)(H, D, M) * ((H * D) ** -0.5)),
        }
    _A_in = _A_setup()

    def _B_setup():
        B, S, D, F = 1, 1, 512, 1376
        return {
            "x": _w((lambda *s: torch.randn(*s, dtype=torch.bfloat16) * 0.05)(B, S, D)),
            "w1": _w((lambda *s: torch.randn(*s, dtype=torch.bfloat16) * 12.8)(D, F) * (D ** -0.5)),
            "w2": _w((lambda *s: torch.randn(*s, dtype=torch.bfloat16) * 0.1)(F, D) * (F ** -0.5)),
        }
    _B_in = _B_setup()

    return {
        "A_x": _A_in["x"],
        "A_c_kv": _A_in["c_kv"],
        "A_w_q": _A_in["w_q"],
        "A_w_uk": _A_in["w_uk"],
        "A_w_uv": _A_in["w_uv"],
        "A_w_o": _A_in["w_o"],
        "B_x": _B_in["x"],
        "B_w1": _B_in["w1"],
        "B_w2": _B_in["w2"],
        "gate_w": _w((lambda *s: torch.randn(*s, dtype=torch.bfloat16) * 0.05)(512) * 16.0),
    }

def reference(A_x, A_c_kv, A_w_q, A_w_uk, A_w_uv, A_w_o, B_x, B_w1, B_w2, gate_w):
    def _A_ref(x, c_kv, w_q, w_uk, w_uv, w_o):
        B, Sq, M = x.shape[0], x.shape[1], x.shape[2]
        Sk = c_kv.shape[1]
        H, D = w_q.shape[1], w_q.shape[2]
        q = torch.einsum("bqm,mhd->bhqd", x, w_q)
        k = torch.einsum("bkc,chd->bhkd", c_kv, w_uk)
        v = torch.einsum("bkc,chd->bhkd", c_kv, w_uv)
        scores = torch.einsum("bhqd,bhkd->bhqk", q, k) * (D ** -0.5)
        off = Sk - Sq
        qi = torch.arange(Sq)[:, None]
        kj = torch.arange(Sk)[None, :]
        cmask = kj <= (qi + off)
        scores = torch.where(cmask[None, None], scores, -1e9)
        p = _softmax(scores, axis=-1)
        ctx = torch.einsum("bhqk,bhkd->bhqd", p, v)
        return torch.einsum("bhqd,hdm->bqm", ctx, w_o)

    def _B_ref(x, w1, w2):
        h = torch.einsum("bsd,df->bsf", x, w1)
        h = _silu(h)
        out = torch.einsum("bsf,fd->bsd", h, w2)
        return out

    x = A_x
    g = _sigmoid((x * gate_w).sum(-1, keepdims=True))
    a = _A_ref(x, A_c_kv, A_w_q, A_w_uk, A_w_uv, A_w_o)
    b = _B_ref(x, B_w1, B_w2)
    return g * a + (1 - g) * b
```

```asm
; @launch grid=(256,1,1) block=(512,1,1) lds=156672
.amdgcn_target "amdgcn-amd-amdhsa--gfx950"
.text
.globl gated_mix__compressed_kv_cla__dense_activation_silu__decode_kernel
.p2align 12
.p2align 8
.type gated_mix__compressed_kv_cla__dense_activation_silu__decode_kernel,@function
gated_mix__compressed_kv_cla__dense_activation_silu__decode_kernel:
    s_cmp_ge_u32 s2, 0x100
    s_cbranch_scc1 L_end
    s_load_dwordx2 s[16:17], s[0:1], 96
    s_getpc_b64 s[4:5]
L_pc:
    s_bfe_u32 s3, s2, 0x30003
    s_lshl_b32 s3, s3, 4
    v_add_u32 v1, s3, v0
    v_lshlrev_b32 v1, 7, v1
    v_min_u32 v1, L_end-L_pc, v1
    v_mov_b32 v3, s5
    v_add_co_u32 v2, vcc, s4, v1
    s_nop 1
    v_addc_co_u32 v3, vcc, 0, v3, vcc
    v_cmp_gt_u32 vcc, 16, v0
    s_and_saveexec_b64 s[4:5], vcc
    s_cbranch_execz L_nopf
    global_load_dword v207, v[2:3], off
L_nopf:
    s_mov_b64 exec, -1
    v_lshrrev_b32 v1, 6, v0
    v_and_b32 v0, 63, v0
    v_readfirstlane_b32 s3, v1
    s_and_b32 s68, s2, 7
    s_bfe_u32 s69, s2, 0x30003
    s_lshr_b32 s70, s2, 6
    s_lshl2_add_u32 s71, s68, s70
    s_and_b32 s72, s69, 1
    s_lshr_b32 s73, s69, 1
    s_lshl3_add_u32 s74, s68, s69
    s_mov_b32 s18, 3276800
    s_mov_b32 s19, 0x00020000
    s_mov_b32 s84, 0
    s_mov_b32 s89, 0
    v_lshrrev_b32 v1, 3, v0
    v_and_b32 v2, 7, v0
    v_lshrrev_b32 v3, 4, v0
    v_and_b32 v4, 15, v0
    s_lshl1_add_u32 s85, s71, s72
    s_lshl_b32 s85, s85, 7
    s_cmp_ge_u32 s3, 4
    s_cbranch_scc1 L_g1
    s_load_dwordx2 s[4:5], s[0:1], 0
    s_load_dwordx2 s[8:9], s[0:1], 16
    s_load_dwordx2 s[12:13], s[0:1], 24
    s_mov_b32 s6, 1024
    s_mov_b32 s7, 0x00020000
    s_mov_b32 s10, 4194304
    s_mov_b32 s11, 0x00020000
    s_mov_b32 s14, 4194304
    s_mov_b32 s15, 0x00020000
    s_and_b32 s75, s85, 0x380
    s_cmp_eq_u32 s75, 0x180
    s_cselect_b32 s75, s73, 0
    s_lshl_b32 s48, s75, 20
    s_lshl_b32 s80, s75, 8
    s_xor_b32 s49, s48, 8192
    s_xor_b32 s50, s48, 16384
    s_xor_b32 s51, s48, 24576
    s_xor_b32 s52, s48, 1048576
    s_xor_b32 s53, s48, 1056768
    s_xor_b32 s54, s48, 1064960
    s_xor_b32 s55, s48, 1073152
    s_xor_b32 s56, s48, 2097152
    s_xor_b32 s57, s48, 2105344
    s_xor_b32 s58, s48, 2113536
    s_xor_b32 s59, s48, 2121728
    s_xor_b32 s60, s48, 3145728
    s_xor_b32 s61, s48, 3153920
    s_xor_b32 s62, s48, 3162112
    s_xor_b32 s63, s48, 3170304
    s_xor_b32 s81, s80, 256
    s_xor_b32 s82, s80, 512
    s_xor_b32 s83, s80, 768
    s_lshl_b32 s75, s3, 6
    v_lshl_add_u32 v5, v1, 3, s75
    s_lshl_b32 s75, s3, 18
    s_add_u32 s75, s75, s85
    v_lshl_add_u32 v6, v1, 15, s75
    v_lshl_add_u32 v6, v2, 4, v6
    s_lshl_b32 s79, s73, 20
    s_add_u32 s79, s79, s75
    v_and_b32 v11, 3, v1
    v_lshl_add_u32 v7, v11, 16, s79
    v_and_b32 v11, 32, v0
    v_lshl_add_u32 v7, v11, 9, v7
    v_xor_b32 v11, v2, v3
    v_lshl_add_u32 v7, v11, 4, v7
    v_xor_b32 v8, 0x8040, v7
    s_mov_b32 s64, 0x2000
    s_mul_i32 s86, s3, 4224
    s_add_u32 s86, s86, 131072
    s_mov_b32 m0, s86
    s_waitcnt lgkmcnt(0)
    buffer_load_dwordx2 v[20:21], v5, s[4:7], s80 offen
    buffer_load_dwordx2 v[22:23], v5, s[4:7], s81 offen
    buffer_load_dwordx2 v[24:25], v5, s[4:7], s82 offen
    buffer_load_dwordx2 v[26:27], v5, s[4:7], s83 offen
    buffer_load_dwordx4 v[100:103], v6, s[8:11], s48 offen
    buffer_load_dwordx4 v[104:107], v6, s[8:11], s49 offen
    buffer_load_dwordx4 v[108:111], v6, s[8:11], s50 offen
    buffer_load_dwordx4 v[112:115], v6, s[8:11], s51 offen
    buffer_load_dwordx4 v[116:119], v6, s[8:11], s52 offen
    buffer_load_dwordx4 v[120:123], v6, s[8:11], s53 offen
    buffer_load_dwordx4 v[124:127], v6, s[8:11], s54 offen
    buffer_load_dwordx4 v[128:131], v6, s[8:11], s55 offen
    buffer_load_dwordx4 v[132:135], v6, s[8:11], s56 offen
    buffer_load_dwordx4 v[136:139], v6, s[8:11], s57 offen
    buffer_load_dwordx4 v[140:143], v6, s[8:11], s58 offen
    buffer_load_dwordx4 v[144:147], v6, s[8:11], s59 offen
    buffer_load_dwordx4 v[148:151], v6, s[8:11], s60 offen
    buffer_load_dwordx4 v[152:155], v6, s[8:11], s61 offen
    buffer_load_dwordx4 v[156:159], v6, s[8:11], s62 offen
    buffer_load_dwordx4 v[160:163], v6, s[8:11], s63 offen
    s_barrier
    buffer_load_dwordx4 v7, s[12:15], 0 offen lds
    s_add_u32 m0, m0, 0x400
    s_nop 0
    buffer_load_dwordx4 v8, s[12:15], 0 offen lds
    s_add_u32 m0, m0, 0x400
    s_nop 0
    buffer_load_dwordx4 v7, s[12:15], s64 offen lds
    s_add_u32 m0, m0, 0x400
    s_nop 0
    buffer_load_dwordx4 v8, s[12:15], s64 offen lds
    s_load_dword s78, s[16:17], 983040
    s_load_dwordx2 s[32:33], s[0:1], 56
    s_load_dwordx2 s[36:37], s[0:1], 64
    s_load_dwordx2 s[40:41], s[0:1], 72
    s_load_dwordx2 s[44:45], s[0:1], 80
    s_mov_b32 s34, 1409024
    s_mov_b32 s35, 0x00020000
    s_mov_b32 s38, 1409024
    s_mov_b32 s39, 0x00020000
    s_mov_b32 s42, 1024
    s_mov_b32 s43, 0x00020000
    s_mov_b32 s46, 1024
    s_mov_b32 s47, 0x00020000
    v_and_b32 v11, 1, v0
    v_cmp_eq_u32 vcc, 1, v11
    v_mov_b32 v11, 0x0c0c0100
    v_mov_b32 v12, 0x01000c0c
    v_cndmask_b32 v11, v11, v12, vcc
    v_mov_b32 v12, 0x0c0c0302
    v_mov_b32 v13, 0x03020c0c
    v_cndmask_b32 v12, v12, v13, vcc
    v_mov_b32 v13, 0x0c0c0c0c
    v_lshrrev_b32 v14, 1, v2
    v_cmp_eq_u32 vcc, 0, v14
    s_nop 1
    v_cndmask_b32 v28, v13, v11, vcc
    v_cndmask_b32 v32, v13, v12, vcc
    v_cmp_eq_u32 vcc, 1, v14
    s_nop 1
    v_cndmask_b32 v29, v13, v11, vcc
    v_cndmask_b32 v33, v13, v12, vcc
    v_cmp_eq_u32 vcc, 2, v14
    s_nop 1
    v_cndmask_b32 v30, v13, v11, vcc
    v_cndmask_b32 v34, v13, v12, vcc
    v_cmp_eq_u32 vcc, 3, v14
    s_nop 1
    v_cndmask_b32 v31, v13, v11, vcc
    v_cndmask_b32 v35, v13, v12, vcc
    v_lshrrev_b32 v11, 3, v4
    s_mul_i32 s75, s3, 320
    s_add_u32 s75, s75, 150144
    v_mul_u32_u24 v12, 160, v11
    v_lshl_add_u32 v12, v2, 4, v12
    v_and_b32 v14, 1, v3
    v_lshl_add_u32 v12, v14, 3, v12
    v_add_u32 v12, s75, v12
    v_lshrrev_b32 v5, 5, v0
    v_cmp_eq_u32 vcc, v11, v5
    v_mov_b32 v13, 156608
    s_nop 0
    v_cndmask_b32 v15, v13, v12, vcc
    v_mul_u32_u24 v12, 160, v2
    v_lshl_add_u32 v12, v3, 4, v12
    v_add_u32 v12, 150144, v12
    v_mov_b32 v13, 151424
    v_cmp_gt_u32 vcc, 8, v4
    s_nop 1
    v_cndmask_b32 v16, v13, v12, vcc
    v_cndmask_b32 v17, v12, v13, vcc
    v_lshrrev_b32 v12, 1, v4
    v_xor_b32 v12, v12, v3
    v_lshl_add_u32 v13, v4, 7, s86
    v_lshl_add_u32 v6, v12, 4, v13
    v_xor_b32 v7, 64, v6
    s_lshr_b32 s75, s71, 3
    s_lshl2_add_u32 s75, s75, s73
    s_lshl2_add_u32 s75, s75, s3
    s_lshl1_add_u32 s75, s75, s72
    s_and_b32 s79, s71, 7
    s_lshl3_add_u32 s75, s75, s79
    s_lshl_b32 s75, s75, 6
    v_lshl_add_u32 v12, v0, 4, s75
    v_mov_b32 v13, 1073741824
    v_cmp_gt_u32 vcc, 4, v0
    s_nop 1
    v_cndmask_b32 v18, v13, v12, vcc
    v_and_b32 v12, 3, v0
    v_lshrrev_b32 v13, 2, v4
    v_lshl_add_u32 v19, v12, 2, v13
    s_waitcnt vmcnt(20)
    v_perm_b32 v36, v20, v20, v28
    v_perm_b32 v37, v20, v20, v29
    v_perm_b32 v38, v20, v20, v30
    v_perm_b32 v39, v20, v20, v31
    v_perm_b32 v40, v20, v20, v32
    v_perm_b32 v41, v20, v20, v33
    v_perm_b32 v42, v20, v20, v34
    v_perm_b32 v43, v20, v20, v35
    v_perm_b32 v44, v21, v21, v28
    v_perm_b32 v45, v21, v21, v29
    v_perm_b32 v46, v21, v21, v30
    v_perm_b32 v47, v21, v21, v31
    v_perm_b32 v48, v21, v21, v32
    v_perm_b32 v49, v21, v21, v33
    v_perm_b32 v50, v21, v21, v34
    v_perm_b32 v51, v21, v21, v35
    v_perm_b32 v52, v22, v22, v28
    v_perm_b32 v53, v22, v22, v29
    v_perm_b32 v54, v22, v22, v30
    v_perm_b32 v55, v22, v22, v31
    v_perm_b32 v56, v22, v22, v32
    v_perm_b32 v57, v22, v22, v33
    v_perm_b32 v58, v22, v22, v34
    v_perm_b32 v59, v22, v22, v35
    v_perm_b32 v60, v23, v23, v28
    v_perm_b32 v61, v23, v23, v29
    v_perm_b32 v62, v23, v23, v30
    v_perm_b32 v63, v23, v23, v31
    v_perm_b32 v64, v23, v23, v32
    v_perm_b32 v65, v23, v23, v33
    v_perm_b32 v66, v23, v23, v34
    v_perm_b32 v67, v23, v23, v35
    v_perm_b32 v68, v24, v24, v28
    v_perm_b32 v69, v24, v24, v29
    v_perm_b32 v70, v24, v24, v30
    v_perm_b32 v71, v24, v24, v31
    v_perm_b32 v72, v24, v24, v32
    v_perm_b32 v73, v24, v24, v33
    v_perm_b32 v74, v24, v24, v34
    v_perm_b32 v75, v24, v24, v35
    v_perm_b32 v76, v25, v25, v28
    v_perm_b32 v77, v25, v25, v29
    v_perm_b32 v78, v25, v25, v30
    v_perm_b32 v79, v25, v25, v31
    v_perm_b32 v80, v25, v25, v32
    v_perm_b32 v81, v25, v25, v33
    v_perm_b32 v82, v25, v25, v34
    v_perm_b32 v83, v25, v25, v35
    v_perm_b32 v84, v26, v26, v28
    v_perm_b32 v85, v26, v26, v29
    v_perm_b32 v86, v26, v26, v30
    v_perm_b32 v87, v26, v26, v31
    v_perm_b32 v88, v26, v26, v32
    v_perm_b32 v89, v26, v26, v33
    v_perm_b32 v90, v26, v26, v34
    v_perm_b32 v91, v26, v26, v35
    v_perm_b32 v92, v27, v27, v28
    v_perm_b32 v93, v27, v27, v29
    v_perm_b32 v94, v27, v27, v30
    v_perm_b32 v95, v27, v27, v31
    v_perm_b32 v96, v27, v27, v32
    v_perm_b32 v97, v27, v27, v33
    v_perm_b32 v98, v27, v27, v34
    v_perm_b32 v99, v27, v27, v35
    s_waitcnt lgkmcnt(0)
    s_not_b32 s76, s78
    s_mul_i32 s77, s78, 0x9E3779B1
    s_add_u32 s77, s77, 0x7F4A7C15
    s_and_b32 s80, s76, 0xfff
    s_lshr_b32 s81, s77, 20
    s_bfe_u32 s82, s77, 0xc0008
    s_bfe_u32 s83, s76, 0xc000c
    s_lshr_b32 s62, s77, 15
    s_xor_b32 s62, s62, s77
    s_and_b32 s62, s62, 0xffffeeee
    s_and_b32 s60, s76, 1
    s_mul_i32 s60, s60, 0x1111
    s_or_b32 s62, s62, s60
    s_mov_b32 s60, 0x00010001
    s_mov_b32 s61, 0x07060302
    v_lshrrev_b32 v19, v19, s62
    s_lshr_b32 s75, s2, 3
    s_and_b32 s79, s75, 0x19
    s_cmp_eq_u32 s79, 9
    s_cselect_b32 s75, 31, s75
    s_sub_u32 s79, s75, 24
    s_lshl1_add_u32 s88, s79, 9
    s_cmp_lt_u32 s79, 4
    s_cselect_b32 s75, s88, s75
    s_mul_i32 s88, s68, 22
    s_add_u32 s88, s88, s75
    s_cmp_lt_u32 s75, 22
    s_cselect_b32 s88, s88, 0x20000
    s_cmp_lt_u32 s88, 172
    s_cselect_b32 s88, s88, 0x20000
    s_and_b32 s75, s88, 3
    s_lshl2_add_u32 s75, s75, s3
    s_lshl_b32 s79, s75, 6
    v_lshl_add_u32 v9, v3, 4, s79
    s_add_u32 s86, s79, 786432
    s_mul_i32 s75, s75, 88064
    s_lshr_b32 s79, s88, 2
    s_lshl_b32 s79, s79, 7
    s_add_u32 s75, s75, s79
    v_mul_u32_u24 v10, 22016, v3
    v_lshl_add_u32 v10, v4, 3, v10
    v_add_u32 v10, s75, v10
    s_lshr_b32 s79, s79, 5
    v_lshrrev_b32 v11, 2, v4
    v_add_u32 v11, s79, v11
    v_lshl_add_u32 v12, v11, 11, s86
    v_and_b32 v13, 3, v0
    v_lshl_add_u32 v12, v13, 4, v12
    v_add_u32 v13, 4294792192, v12
    v_cmp_lt_u32 vcc, 85, v11
    s_nop 1
    v_cndmask_b32 v12, v12, v13, vcc
    v_cndmask_b32 v11, 0, 1, vcc
    v_mov_b32 v13, 1073741824
    v_cmp_eq_u32 vcc, v11, v3
    s_nop 1
    v_cndmask_b32 v242, v13, v12, vcc
    s_lshl_b32 s79, s88, 13
    s_lshl_b32 s75, s3, 8
    s_add_u32 s79, s79, s75
    v_lshl_add_u32 v243, v3, 10, s79
    v_lshl_add_u32 v243, v4, 4, v243
    v_lshlrev_b32 v8, 4, v0
    v_lshl_add_u32 v226, v0, 2, s75
    v_and_b32 v11, 3, v0
    v_lshl_add_u32 v9, v11, 2, v9
    s_mov_b32 s65, 5504
    s_mov_b32 s66, 11008
    s_mov_b32 s67, 16512
    s_mov_b32 s64, 0x1000
    s_waitcnt vmcnt(19)
    v_mfma_f32_16x16x32_bf16 v[180:183], v[36:39], v[100:103], 0
    s_waitcnt vmcnt(18)
    v_mfma_f32_16x16x32_bf16 v[180:183], v[40:43], v[104:107], v[180:183]
    s_waitcnt vmcnt(17)
    v_mfma_f32_16x16x32_bf16 v[180:183], v[44:47], v[108:111], v[180:183]
    s_waitcnt vmcnt(16)
    v_mfma_f32_16x16x32_bf16 v[180:183], v[48:51], v[112:115], v[180:183]
    s_waitcnt vmcnt(15)
    v_mfma_f32_16x16x32_bf16 v[180:183], v[52:55], v[116:119], v[180:183]
    s_waitcnt vmcnt(14)
    v_mfma_f32_16x16x32_bf16 v[180:183], v[56:59], v[120:123], v[180:183]
    s_waitcnt vmcnt(13)
    v_mfma_f32_16x16x32_bf16 v[180:183], v[60:63], v[124:127], v[180:183]
    s_waitcnt vmcnt(12)
    v_mfma_f32_16x16x32_bf16 v[180:183], v[64:67], v[128:131], v[180:183]
    s_waitcnt vmcnt(11)
    v_mfma_f32_16x16x32_bf16 v[180:183], v[68:71], v[132:135], v[180:183]
    s_waitcnt vmcnt(10)
    v_mfma_f32_16x16x32_bf16 v[180:183], v[72:75], v[136:139], v[180:183]
    s_waitcnt vmcnt(9)
    v_mfma_f32_16x16x32_bf16 v[180:183], v[76:79], v[140:143], v[180:183]
    s_waitcnt vmcnt(8)
    v_mfma_f32_16x16x32_bf16 v[180:183], v[80:83], v[144:147], v[180:183]
    s_waitcnt vmcnt(7)
    v_mfma_f32_16x16x32_bf16 v[180:183], v[84:87], v[148:151], v[180:183]
    s_waitcnt vmcnt(6)
    v_mfma_f32_16x16x32_bf16 v[180:183], v[88:91], v[152:155], v[180:183]
    s_waitcnt vmcnt(5)
    v_mfma_f32_16x16x32_bf16 v[180:183], v[92:95], v[156:159], v[180:183]
    s_waitcnt vmcnt(4)
    v_mfma_f32_16x16x32_bf16 v[180:183], v[96:99], v[160:163], v[180:183]
    s_nop 7
    v_cvt_pk_bf16_f32 v12, v180, v181
    v_cvt_pk_bf16_f32 v13, v182, v183
    ds_write_b64 v15, v[12:13]
    s_mov_b32 s75, 0
    s_waitcnt vmcnt(0)
    ds_read_b128 v[164:167], v6 offset:0
    ds_read_b128 v[168:171], v7 offset:0
    ds_read_b128 v[172:175], v6 offset:2048
    ds_read_b128 v[176:179], v7 offset:2048
L_sync1:
    ds_read_b128 v[184:187], v16 offset:0
    ds_read_b128 v[188:191], v16 offset:64
    ds_read_b128 v[192:195], v17 offset:0
    ds_read_b128 v[196:199], v17 offset:64
    s_add_u32 s75, s75, 1
    s_waitcnt lgkmcnt(0)
    v_max3_u32 v11, v184, v186, v188
    v_max3_u32 v12, v190, v192, v194
    v_max3_u32 v11, v11, v196, v198
    v_max_u32 v11, v11, v12
    v_cmp_eq_u32 vcc, -1, v11
    s_cbranch_vccz L_got1
    s_cmp_lt_u32 s75, 20000
    s_cbranch_scc1 L_sync1
L_got1:
    v_mfma_f32_16x16x32_bf16 v[200:203], v[184:187], v[164:167], 0
    v_mfma_f32_16x16x32_bf16 v[200:203], v[188:191], v[168:171], v[200:203]
    v_mfma_f32_16x16x32_bf16 v[200:203], v[192:195], v[172:175], v[200:203]
    v_mfma_f32_16x16x32_bf16 v[200:203], v[196:199], v[176:179], v[200:203]
    s_nop 7
    v_pk_add_f32 v[200:201], v[200:201], v[202:203]
    v_add_f32 v202, v200, v201
    v_add_f32 v200, v200, v201
    s_nop 1
    v_permlane16_swap_b32 v200, v202
    v_add_f32 v200, v200, v202
    v_mul_f32 v201, 0x3e0293ee, v200
    v_mul_f32 v200, 0x3e0293ee, v200
    s_nop 1
    v_permlane32_swap_b32 v200, v201
    v_perm_b32 v204, v201, v200, s61
    v_bfi_b32 v204, s60, v19, v204
    s_nop 1
    v_mov_b32_dpp v205, v204 row_ror:12 row_mask:0xf bank_mask:0xf
    v_mov_b32_dpp v206, v204 row_ror:8 row_mask:0xf bank_mask:0xf
    v_mov_b32_dpp v207, v204 row_ror:4 row_mask:0xf bank_mask:0xf
    buffer_store_dwordx4 v[204:207], v18, s[16:19], 0 offen sc1
    s_branch L_pagea
.p2align 12
L_pagea:
    buffer_load_dword v224, v226, s[4:7], 0 offen
    buffer_load_dword v228, v226, s[40:43], 0 offen
    buffer_load_dwordx2 v[212:213], v10, s[32:35], 0 offen
    buffer_load_dwordx2 v[214:215], v10, s[32:35], s65 offen
    buffer_load_dwordx2 v[216:217], v10, s[32:35], s66 offen
    buffer_load_dwordx2 v[218:219], v10, s[32:35], s67 offen
    buffer_load_dword v225, v9, s[4:7], 0 offen
    v_lshrrev_b32 v11, 2, v0
    s_lshl_b32 s75, s3, 15
    v_lshl_add_u32 v12, v11, 8, s75
    v_and_b32 v11, 31, v0
    v_lshl_add_u32 v248, v11, 3, v12
    v_xor_b32 v249, 32, v248
    v_xor_b32 v250, 64, v248
    v_xor_b32 v251, 96, v248
    v_xor_b32 v252, 128, v248
    v_xor_b32 v253, 160, v248
    v_xor_b32 v254, 192, v248
    v_xor_b32 v255, 224, v248
    v_lshrrev_b32 v11, 5, v0
    v_mul_u32_u24 v11, 272, v11
    v_lshl_add_u32 v11, v14, 7, v11
    v_lshrrev_b32 v12, 2, v4
    v_lshl_add_u32 v11, v12, 5, v11
    v_and_b32 v12, 1, v0
    v_lshl_add_u32 v11, v12, 4, v11
    v_add_u32 v245, 147968, v11
    s_lshl_b32 s75, s70, 5
    s_add_u32 s75, s75, s3
    s_lshl_b32 s75, s75, 6
    s_add_u32 s75, s75, s74
    s_lshl_b32 s75, s75, 8
    s_add_u32 s75, s75, 1048576
    s_and_b32 s79, s74, 15
    s_mov_b32 s86, 0x10000
    v_lshl_add_u32 v11, v3, 17, s75
    v_xor_b32 v12, s79, v4
    v_lshl_add_u32 v246, v12, 4, v11
    v_and_b32 v11, 3, v0
    v_lshlrev_b32 v11, 2, v11
    v_lshrrev_b32 v204, v11, s62
    v_lshrrev_b32 v205, 1, v204
    v_lshrrev_b32 v206, 2, v204
    v_lshrrev_b32 v207, 3, v204
    v_cmp_lt_u32 vcc, 3, v2
    s_nop 1
    v_cndmask_b32 v240, v28, v34, vcc
    v_cndmask_b32 v241, v29, v35, vcc
    v_mov_b32 v247, 0xfffff000
    s_barrier
    ds_read_b64_tr_b16 v[36:37], v248 offset:0
    ds_read_b64_tr_b16 v[52:53], v249 offset:0
    ds_read_b64_tr_b16 v[68:69], v250 offset:0
    ds_read_b64_tr_b16 v[84:85], v251 offset:0
    ds_read_b64_tr_b16 v[100:101], v252 offset:0
    ds_read_b64_tr_b16 v[116:117], v253 offset:0
    ds_read_b64_tr_b16 v[132:133], v254 offset:0
    ds_read_b64_tr_b16 v[148:149], v255 offset:0
    ds_read_b64_tr_b16 v[38:39], v248 offset:4096
    ds_read_b64_tr_b16 v[54:55], v249 offset:4096
    ds_read_b64_tr_b16 v[70:71], v250 offset:4096
    ds_read_b64_tr_b16 v[86:87], v251 offset:4096
    ds_read_b64_tr_b16 v[102:103], v252 offset:4096
    ds_read_b64_tr_b16 v[118:119], v253 offset:4096
    ds_read_b64_tr_b16 v[134:135], v254 offset:4096
    ds_read_b64_tr_b16 v[150:151], v255 offset:4096
    ds_read_b64_tr_b16 v[40:41], v248 offset:8192
    ds_read_b64_tr_b16 v[56:57], v249 offset:8192
    ds_read_b64_tr_b16 v[72:73], v250 offset:8192
    ds_read_b64_tr_b16 v[88:89], v251 offset:8192
    ds_read_b64_tr_b16 v[104:105], v252 offset:8192
    ds_read_b64_tr_b16 v[120:121], v253 offset:8192
    ds_read_b64_tr_b16 v[136:137], v254 offset:8192
    ds_read_b64_tr_b16 v[152:153], v255 offset:8192
    ds_read_b64_tr_b16 v[42:43], v248 offset:12288
    ds_read_b64_tr_b16 v[58:59], v249 offset:12288
    ds_read_b64_tr_b16 v[74:75], v250 offset:12288
    ds_read_b64_tr_b16 v[90:91], v251 offset:12288
    ds_read_b64_tr_b16 v[106:107], v252 offset:12288
    ds_read_b64_tr_b16 v[122:123], v253 offset:12288
    ds_read_b64_tr_b16 v[138:139], v254 offset:12288
    ds_read_b64_tr_b16 v[154:155], v255 offset:12288
    ds_read_b64_tr_b16 v[44:45], v248 offset:16384
    ds_read_b64_tr_b16 v[60:61], v249 offset:16384
    ds_read_b64_tr_b16 v[76:77], v250 offset:16384
    ds_read_b64_tr_b16 v[92:93], v251 offset:16384
    ds_read_b64_tr_b16 v[108:109], v252 offset:16384
    ds_read_b64_tr_b16 v[124:125], v253 offset:16384
    ds_read_b64_tr_b16 v[140:141], v254 offset:16384
    ds_read_b64_tr_b16 v[156:157], v255 offset:16384
    s_barrier
    ds_read_b64_tr_b16 v[46:47], v248 offset:20480
    ds_read_b64_tr_b16 v[62:63], v249 offset:20480
    ds_read_b64_tr_b16 v[78:79], v250 offset:20480
    ds_read_b64_tr_b16 v[94:95], v251 offset:20480
    ds_read_b64_tr_b16 v[110:111], v252 offset:20480
    ds_read_b64_tr_b16 v[126:127], v253 offset:20480
    ds_read_b64_tr_b16 v[142:143], v254 offset:20480
    ds_read_b64_tr_b16 v[158:159], v255 offset:20480
    ds_read_b64_tr_b16 v[48:49], v248 offset:24576
    ds_read_b64_tr_b16 v[64:65], v249 offset:24576
    ds_read_b64_tr_b16 v[80:81], v250 offset:24576
    ds_read_b64_tr_b16 v[96:97], v251 offset:24576
    ds_read_b64_tr_b16 v[112:113], v252 offset:24576
    ds_read_b64_tr_b16 v[128:129], v253 offset:24576
    ds_read_b64_tr_b16 v[144:145], v254 offset:24576
    ds_read_b64_tr_b16 v[160:161], v255 offset:24576
    s_barrier
    ds_read_b64_tr_b16 v[50:51], v248 offset:28672
    ds_read_b64_tr_b16 v[66:67], v249 offset:28672
    ds_read_b64_tr_b16 v[82:83], v250 offset:28672
    ds_read_b64_tr_b16 v[98:99], v251 offset:28672
    ds_read_b64_tr_b16 v[114:115], v252 offset:28672
    ds_read_b64_tr_b16 v[130:131], v253 offset:28672
    ds_read_b64_tr_b16 v[146:147], v254 offset:28672
    ds_read_b64_tr_b16 v[162:163], v255 offset:28672
    s_waitcnt vmcnt(0)
    v_mov_b32_dpp v220, v225 quad_perm:[0,0,0,0] row_mask:0xf bank_mask:0xf
    v_mov_b32_dpp v221, v225 quad_perm:[1,1,1,1] row_mask:0xf bank_mask:0xf
    v_mov_b32_dpp v222, v225 quad_perm:[2,2,2,2] row_mask:0xf bank_mask:0xf
    v_mov_b32_dpp v223, v225 quad_perm:[3,3,3,3] row_mask:0xf bank_mask:0xf
    v_perm_b32 v20, v220, v220, v240
    v_perm_b32 v21, v220, v220, v241
    v_perm_b32 v22, v221, v221, v240
    v_perm_b32 v23, v221, v221, v241
    v_perm_b32 v24, v222, v222, v240
    v_perm_b32 v25, v222, v222, v241
    v_perm_b32 v26, v223, v223, v240
    v_perm_b32 v27, v223, v223, v241
    v_mfma_f32_16x16x32_bf16 v[208:211], v[20:23], v[212:215], 0
    s_nop 0
    v_mfma_f32_16x16x32_bf16 v[208:211], v[24:27], v[216:219], v[208:211]
    v_dot2_f32_bf16 v244, v224, v228, 0
    s_lshl2_add_u32 s75, s3, 156592
    v_mov_b32 v12, s75
    s_nop 0
    v_add_f32_dpp v244, v244, v244 row_ror:8 row_mask:0xf bank_mask:0xf
    s_nop 1
    v_add_f32_dpp v244, v244, v244 row_ror:4 row_mask:0xf bank_mask:0xf
    s_nop 1
    v_add_f32_dpp v244, v244, v244 row_ror:2 row_mask:0xf bank_mask:0xf
    s_nop 1
    v_add_f32_dpp v244, v244, v244 row_ror:1 row_mask:0xf bank_mask:0xf
    v_mov_b32 v11, v244
    s_nop 1
    v_permlane16_swap_b32 v244, v11
    v_add_f32 v244, v244, v11
    v_mov_b32 v11, v244
    s_nop 1
    v_permlane32_swap_b32 v244, v11
    v_add_f32 v244, v244, v11
    ds_write_b32 v12, v244
    v_mov_b32 v12, 156592
    v_add_u32 v208, 0x800, v208
    v_add_u32 v209, 0x800, v209
    v_add_u32 v210, 0x800, v210
    v_add_u32 v211, 0x800, v211
    v_and_or_b32 v208, v208, v247, s80
    v_and_or_b32 v209, v209, v247, s81
    v_and_or_b32 v210, v210, v247, s82
    v_and_or_b32 v211, v211, v247, s83
    buffer_store_dwordx4 v[208:211], v242, s[16:19], 0 offen sc1
    s_waitcnt lgkmcnt(0)
    s_barrier
    buffer_load_dwordx4 v[232:235], v243, s[36:39], 0 offen
    buffer_load_dwordx4 v[236:239], v243, s[36:39], s64 offen
    ds_read_b128 v[228:231], v12
    s_waitcnt lgkmcnt(0)
    v_pk_add_f32 v[228:229], v[228:229], v[230:231]
    v_add_f32 v244, v228, v229
    v_mul_f32 v11, 0xbfb8aa3b, v244
    v_exp_f32 v11, v11
    s_nop 0
    v_add_f32 v11, 1.0, v11
    v_rcp_f32 v244, v11
    v_mov_b32 v11, 156544
    ds_write_b32 v11, v244
    s_waitcnt lgkmcnt(0)
    s_barrier
    ds_read_b128 v[164:167], v245 offset:0
    ds_read_b128 v[168:171], v245 offset:544
    ds_read_b128 v[172:175], v245 offset:1088
    ds_read_b128 v[176:179], v245 offset:1632
    s_waitcnt lgkmcnt(3)
    v_mfma_f32_16x16x32_bf16 v[180:183], v[164:167], v[36:39], 0
    v_mfma_f32_16x16x32_bf16 v[184:187], v[164:167], v[52:55], 0
    s_waitcnt lgkmcnt(2)
    v_mfma_f32_16x16x32_bf16 v[180:183], v[168:171], v[40:43], v[180:183]
    v_mfma_f32_16x16x32_bf16 v[184:187], v[168:171], v[56:59], v[184:187]
    s_waitcnt lgkmcnt(1)
    v_mfma_f32_16x16x32_bf16 v[180:183], v[172:175], v[44:47], v[180:183]
    v_mfma_f32_16x16x32_bf16 v[184:187], v[172:175], v[60:63], v[184:187]
    s_waitcnt lgkmcnt(0)
    v_mfma_f32_16x16x32_bf16 v[180:183], v[176:179], v[48:51], v[180:183]
    v_mfma_f32_16x16x32_bf16 v[184:187], v[176:179], v[64:67], v[184:187]
    v_mfma_f32_16x16x32_bf16 v[188:191], v[164:167], v[68:71], 0
    v_mfma_f32_16x16x32_bf16 v[192:195], v[164:167], v[84:87], 0
    v_mfma_f32_16x16x32_bf16 v[188:191], v[168:171], v[72:75], v[188:191]
    s_nop 4
    v_perm_b32 v196, v184, v180, s61
    v_bfi_b32 v196, s60, v204, v196
    v_mfma_f32_16x16x32_bf16 v[192:195], v[168:171], v[88:91], v[192:195]
    v_perm_b32 v200, v185, v181, s61
    v_bfi_b32 v200, s60, v204, v200
    v_mfma_f32_16x16x32_bf16 v[188:191], v[172:175], v[76:79], v[188:191]
    v_mfma_f32_16x16x32_bf16 v[192:195], v[172:175], v[92:95], v[192:195]
    v_mfma_f32_16x16x32_bf16 v[188:191], v[176:179], v[80:83], v[188:191]
    v_mfma_f32_16x16x32_bf16 v[192:195], v[176:179], v[96:99], v[192:195]
    v_mfma_f32_16x16x32_bf16 v[180:183], v[164:167], v[100:103], 0
    v_mfma_f32_16x16x32_bf16 v[184:187], v[164:167], v[116:119], 0
    v_mfma_f32_16x16x32_bf16 v[180:183], v[168:171], v[104:107], v[180:183]
    s_nop 4
    v_perm_b32 v197, v192, v188, s61
    v_bfi_b32 v197, s60, v205, v197
    v_mfma_f32_16x16x32_bf16 v[184:187], v[168:171], v[120:123], v[184:187]
    v_perm_b32 v201, v193, v189, s61
    v_bfi_b32 v201, s60, v205, v201
    v_mfma_f32_16x16x32_bf16 v[180:183], v[172:175], v[108:111], v[180:183]
    v_mfma_f32_16x16x32_bf16 v[184:187], v[172:175], v[124:127], v[184:187]
    v_mfma_f32_16x16x32_bf16 v[180:183], v[176:179], v[112:115], v[180:183]
    v_mfma_f32_16x16x32_bf16 v[184:187], v[176:179], v[128:131], v[184:187]
    v_mfma_f32_16x16x32_bf16 v[188:191], v[164:167], v[132:135], 0
    v_mfma_f32_16x16x32_bf16 v[192:195], v[164:167], v[148:151], 0
    v_mfma_f32_16x16x32_bf16 v[188:191], v[168:171], v[136:139], v[188:191]
    s_nop 4
    v_perm_b32 v198, v184, v180, s61
    v_bfi_b32 v198, s60, v206, v198
    v_mfma_f32_16x16x32_bf16 v[192:195], v[168:171], v[152:155], v[192:195]
    v_perm_b32 v202, v185, v181, s61
    v_bfi_b32 v202, s60, v206, v202
    v_mfma_f32_16x16x32_bf16 v[188:191], v[172:175], v[140:143], v[188:191]
    v_mfma_f32_16x16x32_bf16 v[192:195], v[172:175], v[156:159], v[192:195]
    v_mfma_f32_16x16x32_bf16 v[188:191], v[176:179], v[144:147], v[188:191]
    v_mfma_f32_16x16x32_bf16 v[192:195], v[176:179], v[160:163], v[192:195]
    s_nop 7
    v_perm_b32 v199, v192, v188, s61
    v_bfi_b32 v199, s60, v207, v199
    buffer_store_dwordx4 v[196:199], v246, s[16:19], 0 offen sc1
    v_perm_b32 v203, v193, v189, s61
    v_bfi_b32 v203, s60, v207, v203
    buffer_store_dwordx4 v[200:203], v246, s[16:19], s86 offen sc1
    s_barrier
    s_and_b32 s79, s88, 1
    s_mul_i32 s79, s79, 992
    s_lshl_b32 s75, s88, 10
    s_sub_u32 s75, s75, s79
    s_add_u32 s75, s75, 786432
    v_and_b32 v11, 0x3e0, v8
    v_add3_u32 v5, s75, v8, v11
    s_lshl_b32 s75, s3, 10
    s_add_u32 s75, s75, 152192
    v_add_u32 v6, s75, v8
    v_mov_b32 v48, 0
    v_mov_b32 v49, 0
    v_mov_b32 v50, 0
    v_mov_b32 v51, 0
    s_cmp_ge_u32 s88, 172
    s_cbranch_scc1 L_noffn
    buffer_load_dwordx4 v[36:39], v5, s[16:19], 0 offen sc1
    s_waitcnt vmcnt(0)
L_chkF:
    v_xor_b32 v36, s80, v36
    v_xor_b32 v37, s81, v37
    v_xor_b32 v38, s82, v38
    v_xor_b32 v39, s83, v39
    v_or3_b32 v11, v36, v37, v38
    v_or_b32 v11, v11, v39
    v_and_b32 v11, 0xfff, v11
    v_cmp_ne_u32 vcc, 0, v11
    s_cbranch_vccnz L_retryF
L_gotF:
    s_mov_b64 exec, -1
    v_permlane32_swap_b32 v36, v38
    v_permlane32_swap_b32 v37, v39
    v_add_f32 v36, v36, v38
    v_add_f32 v37, v37, v39
    s_nop 1
    v_permlane16_swap_b32 v36, v37
    v_add_f32 v36, v36, v37
    s_nop 1
    v_add_f32_dpp v36, v36, v36 row_ror:8 row_mask:0xf bank_mask:0xf
    s_nop 1
    v_add_f32_dpp v36, v36, v36 row_ror:4 row_mask:0xf bank_mask:0xf
    s_nop 1
    v_add_f32_dpp v36, v36, v36 row_ror:2 row_mask:0xf bank_mask:0xf
    v_mul_f32 v11, 0xbfb8aa3b, v36
    v_exp_f32 v11, v11
    s_nop 0
    v_add_f32 v11, 1.0, v11
    v_rcp_f32 v11, v11
    s_nop 0
    v_mul_f32 v36, v36, v11
    s_nop 1
    v_mov_b32_dpp v11, v36 quad_perm:[0,0,2,2] row_mask:0xf bank_mask:0xf
    v_mov_b32_dpp v12, v36 quad_perm:[1,1,3,3] row_mask:0xf bank_mask:0xf
    v_cvt_pk_bf16_f32 v11, v11, v12
    v_perm_b32 v40, v11, v11, v28
    v_perm_b32 v41, v11, v11, v29
    v_perm_b32 v42, v11, v11, v30
    v_perm_b32 v43, v11, v11, v31
    v_perm_b32 v44, v11, v11, v32
    v_perm_b32 v45, v11, v11, v33
    v_perm_b32 v46, v11, v11, v34
    v_perm_b32 v47, v11, v11, v35
    v_mfma_f32_16x16x32_bf16 v[48:51], v[40:43], v[232:235], 0
    s_nop 0
    v_mfma_f32_16x16x32_bf16 v[48:51], v[44:47], v[236:239], v[48:51]
    v_sub_f32 v11, 1.0, v244
    s_nop 6
    v_mul_f32 v48, v11, v48
    v_mul_f32 v49, v11, v49
    v_mul_f32 v50, v11, v50
    v_mul_f32 v51, v11, v51
L_noffn:
    ds_write_b128 v6, v[48:51]
    s_waitcnt lgkmcnt(0)
    s_cmp_ge_u32 s2, 224
    s_cbranch_scc1 L_reduce
    s_barrier
    s_cmp_eq_u32 s2, 176
    s_cbranch_scc1 L_epoch
    s_endpgm
L_reduce:
    s_sub_u32 s79, s2, 224
    s_and_b32 s75, s79, 6
    s_and_b32 s88, s79, 1
    s_lshl1_add_u32 s75, s75, s88
    s_bfe_u32 s88, s79, 0x10003
    s_lshl1_add_u32 s75, s75, s88
    s_lshr_b32 s88, s79, 4
    s_lshl2_add_u32 s79, s88, s75
    s_lshl2_add_u32 s86, s79, s3
    s_lshl_b32 s75, s86, 12
    s_add_u32 s75, s75, 262144
    v_lshl_add_u32 v5, v0, 4, s75
    s_lshl2_add_u32 s75, s3, 156288
    v_and_b32 v11, 3, v0
    v_lshl_add_u32 v6, v11, 6, s75
    v_lshl_add_u32 v6, v3, 4, v6
    v_lshlrev_b32 v7, 4, v4
    v_add_u32 v7, 156288, v7
    s_lshr_b32 s75, s79, 3
    s_and_b32 s88, s79, 3
    s_lshl2_add_u32 s75, s75, s88
    s_bfe_u32 s88, s79, 0x10002
    s_lshl3_add_u32 s75, s75, s88
    s_lshl_b32 s75, s75, 3
    s_cmp_eq_u32 s3, 0
    s_cselect_b32 s75, s75, 1073741824
    v_lshl_add_u32 v11, v11, 1, s75
    v_lshrrev_b32 v12, 2, v0
    v_lshl_add_u32 v11, v12, 4, v11
    v_mov_b32 v12, 1073741824
    v_cmp_gt_u32 vcc, 16, v0
    s_nop 1
    v_cndmask_b32 v8, v12, v11, vcc
    v_not_b32 v56, s80
    v_not_b32 v72, s80
    s_and_b32 s75, s2, 0
    s_lshl2_add_u32 s75, s75, s3
    s_lshl_b32 s75, s75, 12
    s_add_u32 s75, s75, 65536
    v_lshl_add_u32 v9, v0, 6, s75
    s_lshl1_add_u32 s76, s76, 1
    s_or_b32 s77, s77, 1
    s_barrier
    s_barrier
    buffer_load_dwordx2 v[16:17], v9, s[16:19], 0 offen sc1
    s_waitcnt vmcnt(0)
L_chkN:
    v_cmp_ne_u64 vcc, s[76:77], v[16:17]
    s_cbranch_vccnz L_retryN
L_gotN:
    s_mov_b64 exec, -1
    buffer_load_dwordx4 v[40:43], v5, s[16:19], 0 offen offset:0 sc1
    buffer_load_dwordx4 v[44:47], v5, s[16:19], 0 offen offset:1024 sc1
    buffer_load_dwordx4 v[48:51], v5, s[16:19], 0 offen offset:2048 sc1
    buffer_load_dwordx4 v[52:55], v5, s[16:19], 0 offen offset:3072 sc1
    s_waitcnt vmcnt(0)
L_chk5:
    v_xor_b32 v24, s80, v40
    v_xor_b32 v25, s81, v41
    v_xor_b32 v26, s82, v42
    v_xor_b32 v27, s83, v43
    v_xor_b32 v28, s80, v44
    v_xor_b32 v29, s81, v45
    v_xor_b32 v30, s82, v46
    v_xor_b32 v31, s83, v47
    v_xor_b32 v32, s80, v48
    v_xor_b32 v33, s81, v49
    v_xor_b32 v34, s82, v50
    v_xor_b32 v35, s83, v51
    v_xor_b32 v36, s80, v52
    v_xor_b32 v37, s81, v53
    v_xor_b32 v38, s82, v54
    v_xor_b32 v39, s83, v55
    v_or3_b32 v11, v24, v25, v26
    v_or3_b32 v12, v27, v28, v29
    v_or3_b32 v11, v11, v30, v31
    v_or3_b32 v12, v12, v32, v33
    v_or3_b32 v11, v11, v34, v35
    v_or3_b32 v12, v12, v36, v37
    v_or3_b32 v11, v11, v38, v39
    v_bitop3_b32 v11, v11, v12, v247 bitop3:0x54
    v_cmp_ne_u32 vcc, 0, v11
    s_cbranch_vccnz L_retry5
L_got5:
    s_mov_b64 exec, -1
    v_pk_add_f32 v[24:25], v[24:25], v[28:29]
    v_pk_add_f32 v[32:33], v[32:33], v[36:37]
    v_pk_add_f32 v[26:27], v[26:27], v[30:31]
    v_pk_add_f32 v[34:35], v[34:35], v[38:39]
    v_pk_add_f32 v[24:25], v[24:25], v[32:33]
    v_pk_add_f32 v[26:27], v[26:27], v[34:35]
    s_nop 1
    v_permlane32_swap_b32 v24, v26
    v_permlane32_swap_b32 v25, v27
    v_pk_add_f32 v[24:25], v[24:25], v[26:27]
    s_nop 1
    v_permlane16_swap_b32 v24, v25
    v_add_f32 v24, v24, v25
    s_nop 1
    v_add_f32_dpp v24, v24, v24 row_ror:4 row_mask:0xf bank_mask:0xf
    s_nop 1
    v_add_f32_dpp v24, v24, v24 row_ror:8 row_mask:0xf bank_mask:0xf
    ds_write_b32 v6, v24
    s_waitcnt lgkmcnt(0)
    s_barrier
    ds_read_b128 v[24:27], v7
    s_waitcnt lgkmcnt(0)
    v_pk_add_f32 v[24:25], v[24:25], v[26:27]
    v_add_f32 v24, v24, v25
    v_cvt_pk_bf16_f32 v24, v24, v24
    buffer_store_short v24, v8, s[44:47], 0 offen
    s_endpgm
L_epoch:
    s_lshl_b32 s75, s3, 15
    s_add_u32 s75, s75, 131072
    v_lshl_add_u32 v5, v0, 6, s75
    s_lshl1_add_u32 s76, s76, 1
    s_or_b32 s77, s77, 1
    v_mov_b32 v12, 1073741824
    s_cmp_eq_u32 s3, 0
    s_cselect_b32 s75, 0, 1073741824
    s_add_u32 s75, s75, 983040
    v_mov_b32 v11, s75
    v_cmp_eq_u32 vcc, 0, v0
    s_nop 1
    v_cndmask_b32 v9, v12, v11, vcc
    s_add_u32 s75, s78, 1
    v_mov_b32 v10, s75
    s_barrier
    buffer_load_dwordx4 v[24:27], v5, s[16:19], 0 offen sc1
    s_waitcnt vmcnt(0)
L_chkE:
    v_xor_b32 v28, v24, v26
    v_xor_b32 v29, v25, v27
    v_cmp_ne_u64 vcc, s[76:77], v[28:29]
    s_cbranch_vccnz L_retryE
L_gotE:
    s_mov_b64 exec, -1
    s_barrier
    buffer_store_dword v10, v9, s[16:19], 0 offen sc1
    s_endpgm
L_retryF:
    s_mov_b64 exec, vcc
    s_add_u32 s89, s89, 1
    s_cmp_lt_u32 s89, 20000
    s_cbranch_scc0 L_gotF
    buffer_load_dwordx4 v[36:39], v5, s[16:19], 0 offen sc1
    s_waitcnt vmcnt(0)
    s_branch L_chkF
L_retryN:
    s_mov_b64 exec, vcc
    s_add_u32 s89, s89, 1
    s_cmp_lt_u32 s89, 20000
    s_cbranch_scc0 L_gotN
    buffer_load_dwordx2 v[16:17], v9, s[16:19], 0 offen sc1
    s_waitcnt vmcnt(0)
    s_branch L_chkN
L_retry5:
    s_mov_b64 exec, vcc
    s_add_u32 s89, s89, 1
    s_cmp_lt_u32 s89, 20000
    s_cbranch_scc0 L_got5
    buffer_load_dwordx4 v[40:43], v5, s[16:19], 0 offen offset:0 sc1
    buffer_load_dwordx4 v[44:47], v5, s[16:19], 0 offen offset:1024 sc1
    buffer_load_dwordx4 v[48:51], v5, s[16:19], 0 offen offset:2048 sc1
    buffer_load_dwordx4 v[52:55], v5, s[16:19], 0 offen offset:3072 sc1
    s_waitcnt vmcnt(8)
    v_xor_b32 v24, s80, v56
    v_xor_b32 v25, s81, v57
    v_xor_b32 v26, s82, v58
    v_xor_b32 v27, s83, v59
    v_xor_b32 v28, s80, v60
    v_xor_b32 v29, s81, v61
    v_xor_b32 v30, s82, v62
    v_xor_b32 v31, s83, v63
    v_xor_b32 v32, s80, v64
    v_xor_b32 v33, s81, v65
    v_xor_b32 v34, s82, v66
    v_xor_b32 v35, s83, v67
    v_xor_b32 v36, s80, v68
    v_xor_b32 v37, s81, v69
    v_xor_b32 v38, s82, v70
    v_xor_b32 v39, s83, v71
    v_or3_b32 v11, v24, v25, v26
    v_or3_b32 v12, v27, v28, v29
    v_or3_b32 v11, v11, v30, v31
    v_or3_b32 v12, v12, v32, v33
    v_or3_b32 v11, v11, v34, v35
    v_or3_b32 v12, v12, v36, v37
    v_or3_b32 v11, v11, v38, v39
    v_bitop3_b32 v11, v11, v12, v247 bitop3:0x54
    v_cmp_ne_u32 vcc, 0, v11
    s_cbranch_vccz L_got5
    s_mov_b64 exec, vcc
    buffer_load_dwordx4 v[56:59], v5, s[16:19], 0 offen offset:0 sc1
    buffer_load_dwordx4 v[60:63], v5, s[16:19], 0 offen offset:1024 sc1
    buffer_load_dwordx4 v[64:67], v5, s[16:19], 0 offen offset:2048 sc1
    buffer_load_dwordx4 v[68:71], v5, s[16:19], 0 offen offset:3072 sc1
    s_waitcnt vmcnt(8)
    v_xor_b32 v24, s80, v72
    v_xor_b32 v25, s81, v73
    v_xor_b32 v26, s82, v74
    v_xor_b32 v27, s83, v75
    v_xor_b32 v28, s80, v76
    v_xor_b32 v29, s81, v77
    v_xor_b32 v30, s82, v78
    v_xor_b32 v31, s83, v79
    v_xor_b32 v32, s80, v80
    v_xor_b32 v33, s81, v81
    v_xor_b32 v34, s82, v82
    v_xor_b32 v35, s83, v83
    v_xor_b32 v36, s80, v84
    v_xor_b32 v37, s81, v85
    v_xor_b32 v38, s82, v86
    v_xor_b32 v39, s83, v87
    v_or3_b32 v11, v24, v25, v26
    v_or3_b32 v12, v27, v28, v29
    v_or3_b32 v11, v11, v30, v31
    v_or3_b32 v12, v12, v32, v33
    v_or3_b32 v11, v11, v34, v35
    v_or3_b32 v12, v12, v36, v37
    v_or3_b32 v11, v11, v38, v39
    v_bitop3_b32 v11, v11, v12, v247 bitop3:0x54
    v_cmp_ne_u32 vcc, 0, v11
    s_cbranch_vccz L_got5
    s_mov_b64 exec, vcc
    buffer_load_dwordx4 v[72:75], v5, s[16:19], 0 offen offset:0 sc1
    buffer_load_dwordx4 v[76:79], v5, s[16:19], 0 offen offset:1024 sc1
    buffer_load_dwordx4 v[80:83], v5, s[16:19], 0 offen offset:2048 sc1
    buffer_load_dwordx4 v[84:87], v5, s[16:19], 0 offen offset:3072 sc1
    s_waitcnt vmcnt(8)
    s_branch L_chk5
L_retryE:
    s_mov_b64 exec, vcc
    s_add_u32 s89, s89, 1
    s_cmp_lt_u32 s89, 20000
    s_cbranch_scc0 L_gotE
    buffer_load_dwordx4 v[24:27], v5, s[16:19], 0 offen sc1
    s_waitcnt vmcnt(0)
    s_branch L_chkE
.p2align 12
L_pageg:
L_g1:
    s_load_dwordx2 s[20:21], s[0:1], 8
    s_sub_u32 s3, s3, 4
    s_mov_b32 s22, 8388608
    s_mov_b32 s23, 0x00020000
    v_mov_b32 v22, -1
    v_mov_b32 v23, -1
    s_mul_i32 s79, s3, 320
    s_add_u32 s79, s79, 150144
    v_min_u32 v21, 39, v0
    v_lshl_add_u32 v21, v21, 3, s79
    ds_write_b64 v21, v[22:23]
    v_mov_b32 v20, 0
    v_and_b32 v21, 31, v0
    v_lshlrev_b32 v21, 2, v21
    v_add_u32 v21, 151424, v21
    ds_write_b32 v21, v20
    s_lshl3_add_u32 s75, s69, s68
    s_lshl_b32 s75, s75, 9
    s_add_u32 s75, s75, s3
    s_lshl_b32 s75, s75, 8
    v_lshlrev_b32 v20, 1, v3
    v_xor_b32 v20, v20, v4
    v_lshl_add_u32 v21, v3, 10, s75
    v_lshl_add_u32 v6, v20, 4, v21
    v_xor_b32 v7, 0x1080, v6
    s_lshl_b32 s79, s3, 15
    s_mov_b32 m0, s79
    v_lshlrev_b32 v20, 1, v2
    v_xor_b32 v20, v20, v3
    v_lshl_add_u32 v21, v4, 8, s79
    v_lshl_add_u32 v8, v20, 4, v21
    v_xor_b32 v9, 64, v8
    v_xor_b32 v10, 128, v8
    v_xor_b32 v11, 192, v8
    s_mov_b32 s75, 0
    s_waitcnt lgkmcnt(0)
    s_load_dword s78, s[16:17], 983040
    s_load_dwordx2 s[24:25], s[0:1], 32
    s_load_dwordx2 s[28:29], s[0:1], 40
    s_mov_b32 s26, 4194304
    s_mov_b32 s27, 0x00020000
    s_mov_b32 s30, 4194304
    s_mov_b32 s31, 0x00020000
    s_mov_b32 s48, 16384
    s_mov_b32 s49, 524288
    s_mov_b32 s50, 540672
    s_mul_i32 s54, s73, 0x8800
    s_and_b32 s54, s54, 32768
    s_xor_b32 s51, s54, 4096
    s_xor_b32 s52, s54, 32768
    s_xor_b32 s53, s54, 36864
    v_lshrrev_b32 v5, 3, v4
    s_lshl2_add_u32 s86, s70, s3
    s_lshl_b32 s86, s86, 12
    v_xor_b32 v20, v0, v3
    v_lshl_add_u32 v12, v20, 4, s86
    s_mul_i32 s86, s3, 4224
    s_add_u32 s86, s86, 131072
    v_lshrrev_b32 v20, 2, v4
    v_xor_b32 v20, v20, v3
    v_lshl_add_u32 v20, v4, 2, v20
    v_lshl_add_u32 v19, v20, 4, s86
    v_mul_u32_u24 v20, 528, v2
    v_lshl_add_u32 v20, v5, 7, v20
    v_lshl_add_u32 v20, v3, 4, v20
    v_add_u32 v13, s86, v20
    s_mul_i32 s86, s3, 1056
    s_add_u32 s86, s86, 131072
    v_lshrrev_b32 v23, 5, v0
    v_add_u32 v20, v23, v0
    v_lshl_add_u32 v14, v20, 4, s86
    v_and_b32 v20, 1, v3
    v_lshrrev_b32 v21, 2, v2
    v_lshl_add_u32 v20, v20, 1, v21
    v_mul_u32_u24 v20, 544, v20
    v_and_b32 v21, 1, v0
    v_lshl_add_u32 v20, v21, 7, v20
    v_and_b32 v21, 2, v0
    v_mul_u32_u24 v21, 136, v21
    v_add_u32 v20, v20, v21
    v_lshl_add_u32 v20, v23, 4, v20
    v_lshl_add_u32 v20, v5, 3, v20
    s_lshl_b32 s86, s3, 5
    s_add_u32 s86, s86, 147968
    v_add_u32 v15, s86, v20
    v_lshrrev_b32 v23, 5, v0
    s_lshl2_add_u32 s86, s70, s3
    s_lshl_b32 s86, s86, 11
    s_lshl4_add_u32 s86, s74, s86
    s_lshl_b32 s86, s86, 2
    s_add_u32 s86, s86, 131072
    v_lshl_add_u32 v20, v23, 12, s86
    v_mov_b32 v22, 1073741824
    v_and_b32 v21, 31, v0
    v_lshl_add_u32 v20, v21, 4, v20
    v_cmp_gt_u32 vcc, 4, v21
    s_nop 1
    v_cndmask_b32 v16, v22, v20, vcc
    s_lshl_b32 s86, s73, 5
    s_add_u32 s86, s86, s3
    s_lshl_b32 s86, s86, 15
    s_add_u32 s86, s86, s85
    v_and_b32 v20, 3, v1
    v_lshl_add_u32 v17, v20, 17, s86
    v_lshl_add_u32 v17, v23, 13, v17
    v_lshl_add_u32 v17, v2, 4, v17
    s_lshl1_add_u32 s86, s85, s3
    s_lshl_b32 s86, s86, 8
    v_lshl_add_u32 v18, v3, 13, s86
    v_lshl_add_u32 v18, v4, 4, v18
    v_mov_b32 v184, 0
    v_mov_b32 v185, 0
    v_mov_b32 v186, 0
    v_mov_b32 v187, 0
    v_and_b32 v21, 3, v0
    s_lshl_b32 s79, s2, 6
    s_lshl_b32 s88, s3, 17
    s_add_u32 s88, s88, s79
    s_add_u32 s88, s88, 262144
    v_lshrrev_b32 v20, 2, v0
    v_lshl_add_u32 v20, v20, 14, s88
    v_lshl_add_u32 v20, v21, 4, v20
    v_mov_b32 v22, 1073741824
    v_cmp_gt_u32 vcc, 32, v0
    s_nop 1
    v_cndmask_b32 v188, v22, v20, vcc
    s_barrier
    buffer_load_dwordx4 v6, s[20:23], s75 offen lds
    s_add_u32 m0, m0, 0x400
    s_nop 0
    buffer_load_dwordx4 v7, s[20:23], s75 offen lds
    s_add_u32 m0, m0, 0x400
    s_xor_b32 s75, s75, 8192
    buffer_load_dwordx4 v6, s[20:23], s75 offen lds
    s_add_u32 m0, m0, 0x400
    s_nop 0
    buffer_load_dwordx4 v7, s[20:23], s75 offen lds
    s_add_u32 m0, m0, 0x400
    s_xor_b32 s75, s75, 24576
    s_waitcnt lgkmcnt(0)
    s_not_b32 s76, s78
    s_mul_i32 s77, s78, 0x9E3779B1
    s_add_u32 s77, s77, 0x7F4A7C15
    s_and_b32 s80, s76, 0xfff
    s_lshr_b32 s81, s77, 20
    s_bfe_u32 s82, s77, 0xc0008
    s_bfe_u32 s83, s76, 0xc000c
    s_lshr_b32 s62, s77, 15
    s_xor_b32 s62, s62, s77
    s_and_b32 s62, s62, 0xffffeeee
    s_and_b32 s60, s76, 1
    s_mul_i32 s60, s60, 0x1111
    s_or_b32 s62, s62, s60
    s_mov_b32 s60, 0x00010001
    s_mov_b32 s61, 0x07060302
    s_lshl1_add_u32 s76, s76, 1
    s_or_b32 s77, s77, 1
    buffer_store_dwordx4 v[184:187], v16, s[16:19], 0 offen sc1
    buffer_store_dwordx4 v[184:187], v188, s[16:19], 0 offen sc1
    buffer_load_dwordx4 v6, s[20:23], s75 offen lds
    s_add_u32 m0, m0, 0x400
    s_nop 0
    buffer_load_dwordx4 v7, s[20:23], s75 offen lds
    s_add_u32 m0, m0, 0x400
    s_xor_b32 s75, s75, 8192
    v_lshlrev_b32 v20, 2, v3
    v_lshrrev_b32 v20, v20, s62
    v_lshrrev_b32 v201, 1, v20
    v_lshrrev_b32 v202, 2, v20
    v_lshrrev_b32 v203, 3, v20
    v_bfi_b32 v200, v20, 0, s60
    v_bfi_b32 v201, v201, 0, s60
    v_bfi_b32 v202, v202, 0, s60
    v_bfi_b32 v203, v203, 0, s60
    buffer_load_dwordx4 v6, s[20:23], s75 offen lds
    s_add_u32 m0, m0, 0x400
    s_nop 0
    buffer_load_dwordx4 v7, s[20:23], s75 offen lds
    s_add_u32 m0, m0, 0x400
    s_xor_b32 s75, s75, 57344
    buffer_load_dwordx4 v6, s[20:23], s75 offen lds
    s_add_u32 m0, m0, 0x400
    s_nop 0
    buffer_load_dwordx4 v7, s[20:23], s75 offen lds
    s_add_u32 m0, m0, 0x400
    s_xor_b32 s75, s75, 8192
    buffer_load_dwordx4 v6, s[20:23], s75 offen lds
    s_add_u32 m0, m0, 0x400
    s_nop 0
    buffer_load_dwordx4 v7, s[20:23], s75 offen lds
    s_add_u32 m0, m0, 0x400
    s_xor_b32 s75, s75, 24576
    s_waitcnt vmcnt(10)
    ds_read_b128 v[24:27], v8 offset:0
    ds_read_b128 v[28:31], v9 offset:0
    ds_read_b128 v[32:35], v10 offset:0
    ds_read_b128 v[36:39], v11 offset:0
    buffer_load_dwordx4 v6, s[20:23], s75 offen lds
    s_add_u32 m0, m0, 0x400
    s_nop 0
    buffer_load_dwordx4 v7, s[20:23], s75 offen lds
    s_add_u32 m0, m0, 0x400
    s_xor_b32 s75, s75, 8192
    buffer_load_dwordx4 v6, s[20:23], s75 offen lds
    s_add_u32 m0, m0, 0x400
    s_nop 0
    buffer_load_dwordx4 v7, s[20:23], s75 offen lds
    s_add_u32 m0, m0, 0x400
    s_xor_b32 s75, s75, 122880
    s_waitcnt vmcnt(8)
    ds_read_b128 v[40:43], v8 offset:4096
    ds_read_b128 v[44:47], v9 offset:4096
    ds_read_b128 v[48:51], v10 offset:4096
    ds_read_b128 v[52:55], v11 offset:4096
    buffer_load_dwordx4 v6, s[20:23], s75 offen lds
    s_add_u32 m0, m0, 0x400
    s_nop 0
    buffer_load_dwordx4 v7, s[20:23], s75 offen lds
    s_add_u32 m0, m0, 0x400
    s_xor_b32 s75, s75, 8192
    buffer_load_dwordx4 v6, s[20:23], s75 offen lds
    s_add_u32 m0, m0, 0x400
    s_nop 0
    buffer_load_dwordx4 v7, s[20:23], s75 offen lds
    s_add_u32 m0, m0, 0x400
    s_xor_b32 s75, s75, 24576
    s_waitcnt vmcnt(8)
    ds_read_b128 v[56:59], v8 offset:8192
    ds_read_b128 v[60:63], v9 offset:8192
    ds_read_b128 v[64:67], v10 offset:8192
    ds_read_b128 v[68:71], v11 offset:8192
    buffer_load_dwordx4 v6, s[20:23], s75 offen lds
    s_add_u32 m0, m0, 0x400
    s_nop 0
    buffer_load_dwordx4 v7, s[20:23], s75 offen lds
    s_add_u32 m0, m0, 0x400
    s_xor_b32 s75, s75, 8192
    buffer_load_dwordx4 v6, s[20:23], s75 offen lds
    s_add_u32 m0, m0, 0x400
    s_nop 0
    buffer_load_dwordx4 v7, s[20:23], s75 offen lds
    s_add_u32 m0, m0, 0x400
    s_xor_b32 s75, s75, 57344
    s_waitcnt vmcnt(8)
    ds_read_b128 v[72:75], v8 offset:12288
    ds_read_b128 v[76:79], v9 offset:12288
    ds_read_b128 v[80:83], v10 offset:12288
    ds_read_b128 v[84:87], v11 offset:12288
    buffer_load_dwordx4 v6, s[20:23], s75 offen lds
    s_add_u32 m0, m0, 0x400
    s_nop 0
    buffer_load_dwordx4 v7, s[20:23], s75 offen lds
    s_add_u32 m0, m0, 0x400
    s_xor_b32 s75, s75, 8192
    buffer_load_dwordx4 v6, s[20:23], s75 offen lds
    s_add_u32 m0, m0, 0x400
    s_nop 0
    buffer_load_dwordx4 v7, s[20:23], s75 offen lds
    s_add_u32 m0, m0, 0x400
    s_xor_b32 s75, s75, 24576
    s_waitcnt vmcnt(8)
    ds_read_b128 v[88:91], v8 offset:16384
    ds_read_b128 v[92:95], v9 offset:16384
    ds_read_b128 v[96:99], v10 offset:16384
    ds_read_b128 v[100:103], v11 offset:16384
    s_barrier
    buffer_load_dwordx4 v6, s[20:23], s75 offen lds
    s_add_u32 m0, m0, 0x400
    s_nop 0
    buffer_load_dwordx4 v7, s[20:23], s75 offen lds
    s_add_u32 m0, m0, 0x400
    s_xor_b32 s75, s75, 8192
    buffer_load_dwordx4 v6, s[20:23], s75 offen lds
    s_add_u32 m0, m0, 0x400
    s_nop 0
    buffer_load_dwordx4 v7, s[20:23], s75 offen lds
    s_mul_i32 s86, s3, 4224
    s_add_u32 m0, s86, 131072
    s_waitcnt vmcnt(8)
    ds_read_b128 v[104:107], v8 offset:20480
    ds_read_b128 v[108:111], v9 offset:20480
    ds_read_b128 v[112:115], v10 offset:20480
    ds_read_b128 v[116:119], v11 offset:20480
    buffer_load_dwordx4 v12, s[16:19], 0 offen offset:0 sc1 lds
    buffer_load_dwordx4 v12, s[16:19], 0 offen offset:1024 sc1 lds
    buffer_load_dwordx4 v12, s[16:19], 0 offen offset:2048 sc1 lds
    buffer_load_dwordx4 v12, s[16:19], 0 offen offset:3072 sc1 lds
    s_waitcnt vmcnt(8)
    ds_read_b128 v[120:123], v8 offset:24576
    ds_read_b128 v[124:127], v9 offset:24576
    ds_read_b128 v[128:131], v10 offset:24576
    ds_read_b128 v[132:135], v11 offset:24576
    s_barrier
    buffer_load_dwordx4 v[208:211], v17, s[24:27], 0 offen
    buffer_load_dwordx4 v[212:215], v17, s[24:27], s48 offen
    buffer_load_dwordx4 v[216:219], v17, s[24:27], s49 offen
    buffer_load_dwordx4 v[220:223], v17, s[24:27], s50 offen
    s_waitcnt vmcnt(8)
    s_barrier
L_chk2:
    s_waitcnt vmcnt(7)
    ds_read_b128 v[168:171], v19 offset:0
    s_waitcnt vmcnt(6)
    ds_read_b128 v[172:175], v19 offset:1024
    s_waitcnt vmcnt(5)
    ds_read_b128 v[176:179], v19 offset:2048
    s_waitcnt vmcnt(4)
    ds_read_b128 v[180:183], v19 offset:3072
    ds_read_b128 v[136:139], v8 offset:28672
    ds_read_b128 v[140:143], v9 offset:28672
    ds_read_b128 v[144:147], v10 offset:28672
    ds_read_b128 v[148:151], v11 offset:28672
    s_waitcnt lgkmcnt(14)
    s_waitcnt lgkmcnt(7)
    v_xor_b32 v168, v200, v168
    v_xor_b32 v169, v201, v169
    v_xor_b32 v170, v202, v170
    v_xor_b32 v171, v203, v171
    v_bitop3_b32 v20, v168, v169, v170 bitop3:0x80
    v_and_b32 v21, s60, v171
    v_mfma_f32_16x16x32_bf16 v[184:187], v[24:27], v[168:171], 0
    s_waitcnt lgkmcnt(6)
    v_xor_b32 v172, v200, v172
    v_xor_b32 v173, v201, v173
    v_xor_b32 v174, v202, v174
    v_mfma_f32_16x16x32_bf16 v[188:191], v[40:43], v[168:171], 0
    v_xor_b32 v175, v203, v175
    v_bitop3_b32 v20, v20, v172, v173 bitop3:0x80
    v_bitop3_b32 v21, v21, v174, v175 bitop3:0x80
    v_mfma_f32_16x16x32_bf16 v[184:187], v[28:31], v[172:175], v[184:187]
    s_waitcnt lgkmcnt(5)
    v_xor_b32 v176, v200, v176
    v_xor_b32 v177, v201, v177
    v_xor_b32 v178, v202, v178
    v_mfma_f32_16x16x32_bf16 v[188:191], v[44:47], v[172:175], v[188:191]
    v_xor_b32 v179, v203, v179
    v_bitop3_b32 v20, v20, v176, v177 bitop3:0x80
    v_bitop3_b32 v21, v21, v178, v179 bitop3:0x80
    v_mfma_f32_16x16x32_bf16 v[184:187], v[32:35], v[176:179], v[184:187]
    s_waitcnt lgkmcnt(4)
    v_xor_b32 v180, v200, v180
    v_xor_b32 v181, v201, v181
    v_xor_b32 v182, v202, v182
    v_mfma_f32_16x16x32_bf16 v[188:191], v[48:51], v[176:179], v[188:191]
    v_xor_b32 v183, v203, v183
    v_bitop3_b32 v20, v20, v180, v181 bitop3:0x80
    v_bitop3_b32 v21, v21, v182, v183 bitop3:0x80
    v_mfma_f32_16x16x32_bf16 v[184:187], v[36:39], v[180:183], v[184:187]
    v_and_b32 v20, v20, v21
    v_cmp_ne_u32 vcc, s60, v20
    v_mfma_f32_16x16x32_bf16 v[188:191], v[52:55], v[180:183], v[188:191]
    s_cbranch_vccnz L_retry2
L_got2:
    s_and_b32 s75, s85, 0x380
    s_cmp_eq_u32 s75, 0x180
    v_mfma_f32_16x16x32_bf16 v[192:195], v[56:59], v[168:171], 0
    s_cbranch_scc1 L_oc8
    buffer_load_dwordx4 v[224:227], v18, s[28:31], s54 offen offset:0
L_oc8:
    v_mfma_f32_16x16x32_bf16 v[196:199], v[72:75], v[168:171], 0
    s_cbranch_scc1 L_oc7
    buffer_load_dwordx4 v[228:231], v18, s[28:31], s54 offen offset:1024
L_oc7:
    v_mfma_f32_16x16x32_bf16 v[192:195], v[60:63], v[172:175], v[192:195]
    v_add_f32_dpp v200, v184, v184 row_ror:8 row_mask:0xf bank_mask:0x3
    v_add_f32_dpp v201, v185, v185 row_ror:8 row_mask:0xf bank_mask:0x3
    v_mfma_f32_16x16x32_bf16 v[196:199], v[76:79], v[172:175], v[196:199]
    v_add_f32_dpp v202, v186, v186 row_ror:8 row_mask:0xf bank_mask:0x3
    v_add_f32_dpp v203, v187, v187 row_ror:8 row_mask:0xf bank_mask:0x3
    v_mfma_f32_16x16x32_bf16 v[192:195], v[64:67], v[176:179], v[192:195]
    v_add_f32_dpp v200, v188, v188 row_ror:8 row_mask:0xf bank_mask:0xc
    v_add_f32_dpp v201, v189, v189 row_ror:8 row_mask:0xf bank_mask:0xc
    v_mfma_f32_16x16x32_bf16 v[196:199], v[80:83], v[176:179], v[196:199]
    v_add_f32_dpp v202, v190, v190 row_ror:8 row_mask:0xf bank_mask:0xc
    v_add_f32_dpp v203, v191, v191 row_ror:8 row_mask:0xf bank_mask:0xc
    v_mfma_f32_16x16x32_bf16 v[192:195], v[68:71], v[180:183], v[192:195]
    ds_write_b128 v13, v[200:203] offset:0
    v_mfma_f32_16x16x32_bf16 v[196:199], v[84:87], v[180:183], v[196:199]
    s_cbranch_scc1 L_oc6
    buffer_load_dwordx4 v[232:235], v18, s[28:31], s54 offen offset:2048
L_oc6:
    v_mfma_f32_16x16x32_bf16 v[184:187], v[88:91], v[168:171], 0
    s_cbranch_scc1 L_oc5
    buffer_load_dwordx4 v[236:239], v18, s[28:31], s54 offen offset:3072
L_oc5:
    v_mfma_f32_16x16x32_bf16 v[188:191], v[104:107], v[168:171], 0
    buffer_load_dwordx4 v[240:243], v18, s[28:31], s51 offen offset:0
    v_mfma_f32_16x16x32_bf16 v[184:187], v[92:95], v[172:175], v[184:187]
    v_add_f32_dpp v204, v192, v192 row_ror:8 row_mask:0xf bank_mask:0x3
    v_add_f32_dpp v205, v193, v193 row_ror:8 row_mask:0xf bank_mask:0x3
    v_mfma_f32_16x16x32_bf16 v[188:191], v[108:111], v[172:175], v[188:191]
    v_add_f32_dpp v206, v194, v194 row_ror:8 row_mask:0xf bank_mask:0x3
    v_add_f32_dpp v207, v195, v195 row_ror:8 row_mask:0xf bank_mask:0x3
    v_mfma_f32_16x16x32_bf16 v[184:187], v[96:99], v[176:179], v[184:187]
    v_add_f32_dpp v204, v196, v196 row_ror:8 row_mask:0xf bank_mask:0xc
    v_add_f32_dpp v205, v197, v197 row_ror:8 row_mask:0xf bank_mask:0xc
    v_mfma_f32_16x16x32_bf16 v[188:191], v[112:115], v[176:179], v[188:191]
    v_add_f32_dpp v206, v198, v198 row_ror:8 row_mask:0xf bank_mask:0xc
    v_add_f32_dpp v207, v199, v199 row_ror:8 row_mask:0xf bank_mask:0xc
    v_mfma_f32_16x16x32_bf16 v[184:187], v[100:103], v[180:183], v[184:187]
    ds_write_b128 v13, v[204:207] offset:64
    v_mfma_f32_16x16x32_bf16 v[188:191], v[116:119], v[180:183], v[188:191]
    buffer_load_dwordx4 v[244:247], v18, s[28:31], s51 offen offset:1024
    s_waitcnt lgkmcnt(2)
    v_mfma_f32_16x16x32_bf16 v[192:195], v[120:123], v[168:171], 0
    buffer_load_dwordx4 v[248:251], v18, s[28:31], s51 offen offset:2048
    v_mfma_f32_16x16x32_bf16 v[196:199], v[136:139], v[168:171], 0
    buffer_load_dwordx4 v[252:255], v18, s[28:31], s51 offen offset:3072
    v_mfma_f32_16x16x32_bf16 v[192:195], v[124:127], v[172:175], v[192:195]
    v_add_f32_dpp v200, v184, v184 row_ror:8 row_mask:0xf bank_mask:0x3
    v_add_f32_dpp v201, v185, v185 row_ror:8 row_mask:0xf bank_mask:0x3
    v_mfma_f32_16x16x32_bf16 v[196:199], v[140:143], v[172:175], v[196:199]
    v_add_f32_dpp v202, v186, v186 row_ror:8 row_mask:0xf bank_mask:0x3
    v_add_f32_dpp v203, v187, v187 row_ror:8 row_mask:0xf bank_mask:0x3
    v_mfma_f32_16x16x32_bf16 v[192:195], v[128:131], v[176:179], v[192:195]
    v_add_f32_dpp v200, v188, v188 row_ror:8 row_mask:0xf bank_mask:0xc
    v_add_f32_dpp v201, v189, v189 row_ror:8 row_mask:0xf bank_mask:0xc
    v_mfma_f32_16x16x32_bf16 v[196:199], v[144:147], v[176:179], v[196:199]
    v_add_f32_dpp v202, v190, v190 row_ror:8 row_mask:0xf bank_mask:0xc
    v_add_f32_dpp v203, v191, v191 row_ror:8 row_mask:0xf bank_mask:0xc
    v_mfma_f32_16x16x32_bf16 v[192:195], v[132:135], v[180:183], v[192:195]
    ds_write_b128 v13, v[200:203] offset:256
    v_mfma_f32_16x16x32_bf16 v[196:199], v[148:151], v[180:183], v[196:199]
    s_nop 5
    v_add_f32_dpp v204, v192, v192 row_ror:8 row_mask:0xf bank_mask:0x3
    v_add_f32_dpp v205, v193, v193 row_ror:8 row_mask:0xf bank_mask:0x3
    v_add_f32_dpp v206, v194, v194 row_ror:8 row_mask:0xf bank_mask:0x3
    v_add_f32_dpp v207, v195, v195 row_ror:8 row_mask:0xf bank_mask:0x3
    v_add_f32_dpp v204, v196, v196 row_ror:8 row_mask:0xf bank_mask:0xc
    v_add_f32_dpp v205, v197, v197 row_ror:8 row_mask:0xf bank_mask:0xc
    v_add_f32_dpp v206, v198, v198 row_ror:8 row_mask:0xf bank_mask:0xc
    v_add_f32_dpp v207, v199, v199 row_ror:8 row_mask:0xf bank_mask:0xc
    ds_write_b128 v13, v[204:207] offset:320
    s_waitcnt lgkmcnt(0)
    s_barrier
    ds_read_b128 v[152:155], v14 offset:0
    ds_read_b128 v[156:159], v14 offset:4224
    ds_read_b128 v[160:163], v14 offset:8448
    ds_read_b128 v[164:167], v14 offset:12672
    s_waitcnt lgkmcnt(2)
    v_pk_add_f32 v[152:153], v[152:153], v[156:157]
    v_pk_add_f32 v[154:155], v[154:155], v[158:159]
    s_waitcnt lgkmcnt(1)
    v_pk_add_f32 v[152:153], v[152:153], v[160:161]
    v_pk_add_f32 v[154:155], v[154:155], v[162:163]
    s_waitcnt lgkmcnt(0)
    v_pk_add_f32 v[152:153], v[152:153], v[164:165]
    v_pk_add_f32 v[154:155], v[154:155], v[166:167]
    v_max3_f32 v168, v152, v153, v154
    v_max_f32 v168, v168, v155
    s_nop 1
    v_max_f32_dpp v168, v168, v168 row_ror:8 row_mask:0xf bank_mask:0xf
    s_nop 1
    v_max_f32_dpp v168, v168, v168 row_ror:4 row_mask:0xf bank_mask:0xf
    s_nop 1
    v_max_f32_dpp v168, v168, v168 row_ror:2 row_mask:0xf bank_mask:0xf
    s_nop 1
    v_max_f32_dpp v168, v168, v168 row_ror:1 row_mask:0xf bank_mask:0xf
    v_mov_b32 v20, v168
    s_nop 1
    v_permlane16_swap_b32 v168, v20
    v_max_f32 v168, v168, v20
    v_pk_add_f32 v[152:153], v[152:153], v[168:169] op_sel_hi:[1,0] neg_lo:[0,1] neg_hi:[0,1]
    v_pk_add_f32 v[154:155], v[154:155], v[168:169] op_sel_hi:[1,0] neg_lo:[0,1] neg_hi:[0,1]
    v_exp_f32 v152, v152
    v_exp_f32 v153, v153
    v_exp_f32 v154, v154
    v_exp_f32 v155, v155
    v_cvt_pk_bf16_f32 v22, v152, v153
    v_cvt_pk_bf16_f32 v23, v154, v155
    ds_write_b64 v15, v[22:23]
    v_add_f32 v169, v152, v153
    v_add_f32 v20, v154, v155
    v_add_f32 v169, v169, v20
    v_mov_b32 v21, 156544
    v_xor_b32 v170, s76, v168
    s_waitcnt lgkmcnt(0)
    s_barrier
    ds_read_b32 v19, v21
    s_and_b32 s75, s85, 0x380
    s_cmp_eq_u32 s75, 0x180
    s_cbranch_scc1 L_oeQ
    buffer_load_dwordx4 v[24:27], v18, s[28:31], s52 offen offset:0
    buffer_load_dwordx4 v[28:31], v18, s[28:31], s52 offen offset:1024
L_oeQ:
    v_add_f32_dpp v169, v169, v169 row_ror:8 row_mask:0xf bank_mask:0xf
    s_nop 1
    v_add_f32_dpp v169, v169, v169 row_ror:4 row_mask:0xf bank_mask:0xf
    s_nop 1
    v_add_f32_dpp v169, v169, v169 row_ror:2 row_mask:0xf bank_mask:0xf
    s_nop 1
    v_add_f32_dpp v169, v169, v169 row_ror:1 row_mask:0xf bank_mask:0xf
    v_mov_b32 v20, v169
    s_nop 1
    v_permlane16_swap_b32 v169, v20
    v_add_f32 v169, v169, v20
    v_xor_b32 v171, s77, v169
    buffer_store_dwordx4 v[168:171], v16, s[16:19], 0 offen sc1
    s_branch L_pagem
.p2align 12
L_pagem:
    s_and_b32 s75, s85, 0x380
    s_cmp_eq_u32 s75, 0x180
    s_cbranch_scc0 L_omP
    buffer_load_dwordx4 v[224:227], v18, s[28:31], s54 offen offset:0
    buffer_load_dwordx4 v[228:231], v18, s[28:31], s54 offen offset:1024
    buffer_load_dwordx4 v[232:235], v18, s[28:31], s54 offen offset:2048
    buffer_load_dwordx4 v[236:239], v18, s[28:31], s54 offen offset:3072
L_omP:
    s_mul_i32 s75, s3, 5120
    v_mul_u32_u24 v20, 160, v1
    v_lshl_add_u32 v20, v2, 4, v20
    v_add_u32 v6, s75, v20
    s_waitcnt vmcnt(11)
    s_and_b32 s75, s85, 0x380
    s_cmp_eq_u32 s75, 0x180
    s_cbranch_scc0 L_omw
    s_waitcnt vmcnt(9)
L_omw:
    ds_write_b128 v6, v[208:211] offset:0
    ds_write_b128 v6, v[212:215] offset:1280
    ds_write_b128 v6, v[216:219] offset:2560
    ds_write_b128 v6, v[220:223] offset:3840
    v_lshrrev_b32 v20, 2, v0
    v_mul_u32_u24 v20, 160, v20
    v_and_b32 v21, 3, v0
    v_lshl_add_u32 v7, v21, 3, v20
    s_lshl2_add_u32 s75, s71, s73
    s_lshl2_add_u32 s75, s75, s3
    s_lshl_b32 s75, s75, 12
    s_add_u32 s75, s75, 1048576
    v_lshl_add_u32 v8, v0, 4, s75
    s_lshl_b32 s88, s3, 12
    s_add_u32 s88, s88, 24576
    v_lshl_add_u32 v20, v4, 8, s88
    v_xor_b32 v22, v4, v3
    v_lshl_add_u32 v208, v22, 4, v20
    v_xor_b32 v209, 64, v208
    v_xor_b32 v210, 128, v208
    v_xor_b32 v211, 192, v208
    v_lshlrev_b32 v20, 2, v3
    v_lshrrev_b32 v20, v20, s62
    v_lshrrev_b32 v213, 1, v20
    v_lshrrev_b32 v214, 2, v20
    v_lshrrev_b32 v215, 3, v20
    v_bfi_b32 v212, v20, 0, s60
    v_bfi_b32 v213, v213, 0, s60
    v_bfi_b32 v214, v214, 0, s60
    v_bfi_b32 v215, v215, 0, s60
    s_lshl2_add_u32 s75, s71, s3
    s_lshl_b32 s75, s75, 10
    s_add_u32 s75, s75, 131072
    v_lshl_add_u32 v9, v0, 4, s75
    v_lshrrev_b32 v23, 2, v4
    s_lshl3_add_u32 s75, s3, 156560
    v_mov_b32 v16, s75
    v_lshlrev_b32 v17, 3, v21
    v_add_u32 v17, 156560, v17
    s_mul_i32 s75, s3, 160
    s_add_u32 s75, s75, 151552
    s_lshr_b32 s79, s54, 10
    v_xor_b32 v20, s79, v0
    v_lshl_add_u32 v10, v20, 1, s75
    v_mul_u32_u24 v20, 160, v21
    v_lshl_add_u32 v20, v3, 4, v20
    v_add_u32 v20, 151552, v20
    v_mov_b32 v22, 151424
    v_cmp_eq_u32 vcc, 0, v23
    s_nop 1
    v_cndmask_b32 v11, v22, v20, vcc
    v_cmp_eq_u32 vcc, 1, v23
    s_nop 1
    v_cndmask_b32 v12, v22, v20, vcc
    s_lshl_b32 s79, s2, 6
    s_lshl_b32 s75, s3, 17
    s_add_u32 s75, s75, s79
    s_add_u32 s75, s75, 262144
    v_lshrrev_b32 v20, 2, v0
    v_lshl_add_u32 v20, v20, 14, s75
    v_lshl_add_u32 v20, v21, 4, v20
    v_mov_b32 v22, 1073741824
    v_cmp_gt_u32 vcc, 32, v0
    s_nop 1
    v_cndmask_b32 v13, v22, v20, vcc
    s_lshl_b32 s75, s3, 10
    s_add_u32 s75, s75, 152192
    v_lshl_add_u32 v14, v0, 4, s75
    s_add_u32 s75, s79, 65536
    s_cmp_eq_u32 s3, 0
    s_cselect_b32 s75, s75, 1073741824
    v_lshl_add_u32 v20, v23, 14, s75
    v_lshl_add_u32 v20, v21, 4, v20
    v_cmp_gt_u32 vcc, 4, v0
    s_nop 1
    v_cndmask_b32 v6, v22, v20, vcc
    v_mov_b32 v216, s76
    v_mov_b32 v217, s77
    v_mov_b32 v218, s76
    v_mov_b32 v219, s77
    v_mov_b32 v15, 0xfffff000
    s_mov_b32 s86, 0x05040100
    s_mov_b32 s87, 0x07060302
    s_waitcnt lgkmcnt(0)
    s_barrier
    s_and_b32 s75, s85, 0x380
    s_cmp_eq_u32 s75, 0x180
    s_cbranch_scc0 L_oeU
    buffer_load_dwordx4 v[24:27], v18, s[28:31], s52 offen offset:0
    buffer_load_dwordx4 v[28:31], v18, s[28:31], s52 offen offset:1024
L_oeU:
    buffer_load_dwordx4 v[32:35], v18, s[28:31], s52 offen offset:2048
    buffer_load_dwordx4 v[36:39], v18, s[28:31], s52 offen offset:3072
    ds_read_b64_tr_b16 v[88:89], v7 offset:0
    ds_read_b64_tr_b16 v[90:91], v7 offset:2560
    ds_read_b64_tr_b16 v[92:93], v7 offset:5120
    ds_read_b64_tr_b16 v[94:95], v7 offset:7680
    ds_read_b64_tr_b16 v[96:97], v7 offset:10240
    ds_read_b64_tr_b16 v[98:99], v7 offset:12800
    ds_read_b64_tr_b16 v[100:101], v7 offset:15360
    ds_read_b64_tr_b16 v[102:103], v7 offset:17920
    ds_read_b64_tr_b16 v[104:105], v7 offset:32
    ds_read_b64_tr_b16 v[106:107], v7 offset:2592
    ds_read_b64_tr_b16 v[108:109], v7 offset:5152
    ds_read_b64_tr_b16 v[110:111], v7 offset:7712
    ds_read_b64_tr_b16 v[112:113], v7 offset:10272
    ds_read_b64_tr_b16 v[114:115], v7 offset:12832
    ds_read_b64_tr_b16 v[116:117], v7 offset:15392
    ds_read_b64_tr_b16 v[118:119], v7 offset:17952
    ds_read_b64_tr_b16 v[120:121], v7 offset:64
    ds_read_b64_tr_b16 v[122:123], v7 offset:2624
    ds_read_b64_tr_b16 v[124:125], v7 offset:5184
    ds_read_b64_tr_b16 v[126:127], v7 offset:7744
    ds_read_b64_tr_b16 v[128:129], v7 offset:10304
    ds_read_b64_tr_b16 v[130:131], v7 offset:12864
    ds_read_b64_tr_b16 v[132:133], v7 offset:15424
    ds_read_b64_tr_b16 v[134:135], v7 offset:17984
    ds_read_b64_tr_b16 v[136:137], v7 offset:96
    ds_read_b64_tr_b16 v[138:139], v7 offset:2656
    ds_read_b64_tr_b16 v[140:141], v7 offset:5216
    ds_read_b64_tr_b16 v[142:143], v7 offset:7776
    ds_read_b64_tr_b16 v[144:145], v7 offset:10336
    ds_read_b64_tr_b16 v[146:147], v7 offset:12896
    ds_read_b64_tr_b16 v[148:149], v7 offset:15456
    ds_read_b64_tr_b16 v[150:151], v7 offset:18016
    s_waitcnt vmcnt(4)
    v_perm_b32 v56, v228, v224, s86
    v_perm_b32 v57, v236, v232, s86
    v_perm_b32 v58, v244, v240, s86
    v_perm_b32 v59, v252, v248, s86
    v_perm_b32 v60, v228, v224, s87
    v_perm_b32 v61, v236, v232, s87
    v_perm_b32 v62, v244, v240, s87
    v_perm_b32 v63, v252, v248, s87
    v_perm_b32 v64, v229, v225, s86
    v_perm_b32 v65, v237, v233, s86
    v_perm_b32 v66, v245, v241, s86
    v_perm_b32 v67, v253, v249, s86
    v_perm_b32 v68, v229, v225, s87
    v_perm_b32 v69, v237, v233, s87
    v_perm_b32 v70, v245, v241, s87
    v_perm_b32 v71, v253, v249, s87
    v_perm_b32 v72, v230, v226, s86
    v_perm_b32 v73, v238, v234, s86
    v_perm_b32 v74, v246, v242, s86
    v_perm_b32 v75, v254, v250, s86
    v_perm_b32 v76, v230, v226, s87
    v_perm_b32 v77, v238, v234, s87
    v_perm_b32 v78, v246, v242, s87
    v_perm_b32 v79, v254, v250, s87
    v_perm_b32 v80, v231, v227, s86
    v_perm_b32 v81, v239, v235, s86
    v_perm_b32 v82, v247, v243, s86
    v_perm_b32 v83, v255, v251, s86
    v_perm_b32 v84, v231, v227, s87
    v_perm_b32 v85, v239, v235, s87
    v_perm_b32 v86, v247, v243, s87
    v_perm_b32 v87, v255, v251, s87
    buffer_load_dwordx4 v[200:203], v9, s[16:19], 0 offen sc1
    buffer_load_dwordx4 v[40:43], v18, s[28:31], s53 offen offset:0
    buffer_load_dwordx4 v[44:47], v18, s[28:31], s53 offen offset:1024
    buffer_load_dwordx4 v[48:51], v18, s[28:31], s53 offen offset:2048
    buffer_load_dwordx4 v[52:55], v18, s[28:31], s53 offen offset:3072
    s_cmp_lg_u32 s2, s2
    s_waitcnt vmcnt(4)
L_chkM:
    v_xor_b32 v20, v200, v202
    v_xor_b32 v21, v201, v203
    v_cmp_ne_u64 vcc, s[76:77], v[20:21]
    s_cbranch_vccnz L_retryM
L_gotM:
    s_mov_b64 exec, -1
    s_mov_b32 m0, s88
    s_nop 0
    buffer_load_dwordx4 v8, s[16:19], 0 offen offset:0 sc1 lds
    buffer_load_dwordx4 v8, s[16:19], 0 offen offset:1024 sc1 lds
    buffer_load_dwordx4 v8, s[16:19], 0 offen offset:2048 sc1 lds
    buffer_load_dwordx4 v8, s[16:19], 0 offen offset:3072 sc1 lds
    v_max_f32_dpp v22, v200, v200 row_ror:8 row_mask:0xf bank_mask:0xf
    s_nop 1
    v_max_f32_dpp v22, v22, v22 row_ror:4 row_mask:0xf bank_mask:0xf
    v_mov_b32 v21, v22
    s_nop 1
    v_permlane16_swap_b32 v22, v21
    v_max_f32 v22, v22, v21
    v_mov_b32 v21, v22
    s_nop 1
    v_permlane32_swap_b32 v22, v21
    v_max_f32 v22, v22, v21
    v_sub_f32 v204, v200, v22
    v_exp_f32 v204, v204
    s_nop 0
    v_mul_f32 v23, v201, v204
    s_nop 1
    v_add_f32_dpp v23, v23, v23 row_ror:8 row_mask:0xf bank_mask:0xf
    s_nop 1
    v_add_f32_dpp v23, v23, v23 row_ror:4 row_mask:0xf bank_mask:0xf
    v_mov_b32 v21, v23
    s_nop 1
    v_permlane16_swap_b32 v23, v21
    v_add_f32 v23, v23, v21
    v_mov_b32 v21, v23
    s_nop 1
    v_permlane32_swap_b32 v23, v21
    v_add_f32 v23, v23, v21
    ds_write_b64 v16, v[22:23]
    s_cbranch_scc1 L_wo1
    s_waitcnt vmcnt(4)
L_wo1:
    v_perm_b32 v152, v28, v24, s86
    v_perm_b32 v153, v36, v32, s86
    v_perm_b32 v154, v44, v40, s86
    v_perm_b32 v155, v52, v48, s86
    v_perm_b32 v156, v28, v24, s87
    v_perm_b32 v157, v36, v32, s87
    v_perm_b32 v158, v44, v40, s87
    v_perm_b32 v159, v52, v48, s87
    v_perm_b32 v160, v29, v25, s86
    v_perm_b32 v161, v37, v33, s86
    v_perm_b32 v162, v45, v41, s86
    v_perm_b32 v163, v53, v49, s86
    v_perm_b32 v164, v29, v25, s87
    v_perm_b32 v165, v37, v33, s87
    v_perm_b32 v166, v45, v41, s87
    v_perm_b32 v167, v53, v49, s87
    v_perm_b32 v168, v30, v26, s86
    v_perm_b32 v169, v38, v34, s86
    v_perm_b32 v170, v46, v42, s86
    v_perm_b32 v171, v54, v50, s86
    v_perm_b32 v172, v30, v26, s87
    v_perm_b32 v173, v38, v34, s87
    v_perm_b32 v174, v46, v42, s87
    v_perm_b32 v175, v54, v50, s87
    v_perm_b32 v176, v31, v27, s86
    v_perm_b32 v177, v39, v35, s86
    v_perm_b32 v178, v47, v43, s86
    v_perm_b32 v179, v55, v51, s86
    v_perm_b32 v180, v31, v27, s87
    v_perm_b32 v181, v39, v35, s87
    v_perm_b32 v182, v47, v43, s87
    v_perm_b32 v183, v55, v51, s87
    s_waitcnt vmcnt(0) lgkmcnt(0)
    buffer_store_dwordx4 v[216:219], v6, s[16:19], 0 offen sc1
L_chk3:
    ds_read_b128 v[224:227], v208
    ds_read_b128 v[228:231], v209
    ds_read_b128 v[232:235], v210
    ds_read_b128 v[236:239], v211
    s_waitcnt lgkmcnt(3)
    v_xor_b32 v224, v212, v224
    v_xor_b32 v225, v213, v225
    v_xor_b32 v226, v214, v226
    v_xor_b32 v227, v215, v227
    v_bitop3_b32 v20, v224, v225, v226 bitop3:0x80
    v_and_b32 v21, s60, v227
    v_mfma_f32_16x16x32_bf16 v[184:187], v[224:227], v[88:91], 0
    s_waitcnt lgkmcnt(2)
    v_xor_b32 v228, v212, v228
    v_xor_b32 v229, v213, v229
    v_xor_b32 v230, v214, v230
    v_mfma_f32_16x16x32_bf16 v[192:195], v[224:227], v[120:123], 0
    v_xor_b32 v231, v215, v231
    v_bitop3_b32 v20, v20, v228, v229 bitop3:0x80
    v_bitop3_b32 v21, v21, v230, v231 bitop3:0x80
    v_mfma_f32_16x16x32_bf16 v[184:187], v[228:231], v[92:95], v[184:187]
    s_waitcnt lgkmcnt(1)
    v_xor_b32 v232, v212, v232
    v_xor_b32 v233, v213, v233
    v_xor_b32 v234, v214, v234
    v_mfma_f32_16x16x32_bf16 v[192:195], v[228:231], v[124:127], v[192:195]
    v_xor_b32 v235, v215, v235
    v_bitop3_b32 v20, v20, v232, v233 bitop3:0x80
    v_bitop3_b32 v21, v21, v234, v235 bitop3:0x80
    v_mfma_f32_16x16x32_bf16 v[184:187], v[232:235], v[96:99], v[184:187]
    s_waitcnt lgkmcnt(0)
    v_xor_b32 v236, v212, v236
    v_xor_b32 v237, v213, v237
    v_xor_b32 v238, v214, v238
    v_mfma_f32_16x16x32_bf16 v[192:195], v[232:235], v[128:131], v[192:195]
    v_xor_b32 v239, v215, v239
    v_bitop3_b32 v20, v20, v236, v237 bitop3:0x80
    v_bitop3_b32 v21, v21, v238, v239 bitop3:0x80
    v_mfma_f32_16x16x32_bf16 v[184:187], v[236:239], v[100:103], v[184:187]
    v_and_b32 v20, v20, v21
    v_cmp_ne_u32 vcc, s60, v20
    v_mfma_f32_16x16x32_bf16 v[192:195], v[236:239], v[132:135], v[192:195]
    s_cbranch_vccnz L_retry3
L_got3:
    v_mfma_f32_16x16x32_bf16 v[188:191], v[224:227], v[104:107], 0
    v_mfma_f32_16x16x32_bf16 v[196:199], v[224:227], v[136:139], 0
    v_mfma_f32_16x16x32_bf16 v[188:191], v[228:231], v[108:111], v[188:191]
    s_nop 0
    v_mul_f32_dpp v200, v204, v184 row_newbcast:0 row_mask:0xf bank_mask:0xf
    s_nop 1
    v_mul_f32_dpp v202, v204, v192 row_newbcast:0 row_mask:0xf bank_mask:0xf
    v_mfma_f32_16x16x32_bf16 v[196:199], v[228:231], v[140:143], v[196:199]
    v_fmac_f32_dpp v200, v204, v185 row_newbcast:4 row_mask:0xf bank_mask:0xf
    v_fmac_f32_dpp v202, v204, v193 row_newbcast:4 row_mask:0xf bank_mask:0xf
    v_mfma_f32_16x16x32_bf16 v[188:191], v[232:235], v[112:115], v[188:191]
    v_fmac_f32_dpp v200, v204, v186 row_newbcast:8 row_mask:0xf bank_mask:0xf
    v_fmac_f32_dpp v202, v204, v194 row_newbcast:8 row_mask:0xf bank_mask:0xf
    v_mfma_f32_16x16x32_bf16 v[196:199], v[232:235], v[144:147], v[196:199]
    v_fmac_f32_dpp v200, v204, v187 row_newbcast:12 row_mask:0xf bank_mask:0xf
    v_fmac_f32_dpp v202, v204, v195 row_newbcast:12 row_mask:0xf bank_mask:0xf
    v_mfma_f32_16x16x32_bf16 v[188:191], v[236:239], v[116:119], v[188:191]
    s_nop 0
    v_permlane32_swap_b32 v200, v202
    v_add_f32 v200, v200, v202
    v_mfma_f32_16x16x32_bf16 v[196:199], v[236:239], v[148:151], v[196:199]
    s_nop 3
    v_mul_f32_dpp v201, v204, v188 row_newbcast:0 row_mask:0xf bank_mask:0xf
    s_nop 2
    v_mul_f32_dpp v203, v204, v196 row_newbcast:0 row_mask:0xf bank_mask:0xf
    v_fmac_f32_dpp v201, v204, v189 row_newbcast:4 row_mask:0xf bank_mask:0xf
    s_nop 0
    v_fmac_f32_dpp v203, v204, v197 row_newbcast:4 row_mask:0xf bank_mask:0xf
    v_fmac_f32_dpp v201, v204, v190 row_newbcast:8 row_mask:0xf bank_mask:0xf
    s_nop 0
    v_fmac_f32_dpp v203, v204, v198 row_newbcast:8 row_mask:0xf bank_mask:0xf
    v_fmac_f32_dpp v201, v204, v191 row_newbcast:12 row_mask:0xf bank_mask:0xf
    s_nop 0
    v_fmac_f32_dpp v203, v204, v199 row_newbcast:12 row_mask:0xf bank_mask:0xf
    s_nop 1
    v_permlane32_swap_b32 v201, v203
    v_add_f32 v201, v201, v203
    s_nop 1
    v_permlane16_swap_b32 v200, v201
    v_add_f32 v200, v200, v201
    v_cvt_pk_bf16_f32 v200, v200, v200
    ds_write_b16 v10, v200
    s_waitcnt lgkmcnt(0)
    s_barrier
    ds_read_b64 v[22:23], v17
    ds_read_b128 v[208:211], v11 offset:0
    ds_read_b128 v[212:215], v11 offset:64
    ds_read_b128 v[216:219], v12 offset:0
    ds_read_b128 v[220:223], v12 offset:64
    ds_read_b128 v[248:251], v14
    s_waitcnt lgkmcnt(5)
    v_max_f32_dpp v20, v22, v22 quad_perm:[1,0,3,2] row_mask:0xf bank_mask:0xf
    s_waitcnt lgkmcnt(4)
    v_mfma_f32_16x16x32_bf16 v[184:187], v[208:211], v[56:59], 0
    v_max_f32_dpp v20, v20, v20 quad_perm:[2,3,0,1] row_mask:0xf bank_mask:0xf
    v_mfma_f32_16x16x32_bf16 v[188:191], v[208:211], v[60:63], 0
    v_sub_f32 v22, v22, v20
    v_exp_f32 v22, v22
    s_waitcnt lgkmcnt(3)
    v_mfma_f32_16x16x32_bf16 v[184:187], v[212:215], v[152:155], v[184:187]
    v_mul_f32 v23, v23, v22
    v_mul_f32 v22, v22, v19
    v_mfma_f32_16x16x32_bf16 v[188:191], v[212:215], v[156:159], v[188:191]
    v_add_f32_dpp v23, v23, v23 quad_perm:[1,0,3,2] row_mask:0xf bank_mask:0xf
    s_waitcnt lgkmcnt(2)
    v_mfma_f32_16x16x32_bf16 v[184:187], v[216:219], v[72:75], v[184:187]
    v_add_f32_dpp v23, v23, v23 quad_perm:[2,3,0,1] row_mask:0xf bank_mask:0xf
    v_rcp_f32 v23, v23
    v_mfma_f32_16x16x32_bf16 v[188:191], v[216:219], v[76:79], v[188:191]
    s_nop 0
    v_mul_f32_dpp v200, v22, v23 quad_perm:[0,0,0,0] row_mask:0xf bank_mask:0xf
    v_mul_f32_dpp v201, v22, v23 quad_perm:[1,1,1,1] row_mask:0xf bank_mask:0xf
    s_waitcnt lgkmcnt(1)
    v_mfma_f32_16x16x32_bf16 v[184:187], v[220:223], v[168:171], v[184:187]
    v_mul_f32_dpp v202, v22, v23 quad_perm:[2,2,2,2] row_mask:0xf bank_mask:0xf
    v_mul_f32_dpp v203, v22, v23 quad_perm:[3,3,3,3] row_mask:0xf bank_mask:0xf
    v_mfma_f32_16x16x32_bf16 v[188:191], v[220:223], v[172:175], v[188:191]
    s_waitcnt lgkmcnt(0)
    v_mfma_f32_16x16x32_bf16 v[192:195], v[208:211], v[64:67], 0
    v_mfma_f32_16x16x32_bf16 v[196:199], v[208:211], v[68:71], 0
    v_mfma_f32_16x16x32_bf16 v[192:195], v[212:215], v[160:163], v[192:195]
    s_nop 0
    v_fmac_f32 v248, v200, v184
    s_nop 1
    v_fmac_f32 v249, v200, v188
    v_mfma_f32_16x16x32_bf16 v[196:199], v[212:215], v[164:167], v[196:199]
    v_fmac_f32 v248, v201, v185
    v_fmac_f32 v249, v201, v189
    v_mfma_f32_16x16x32_bf16 v[192:195], v[216:219], v[80:83], v[192:195]
    v_fmac_f32 v248, v202, v186
    v_fmac_f32 v249, v202, v190
    v_mfma_f32_16x16x32_bf16 v[196:199], v[216:219], v[84:87], v[196:199]
    v_fmac_f32 v248, v203, v187
    v_fmac_f32 v249, v203, v191
    v_mfma_f32_16x16x32_bf16 v[192:195], v[220:223], v[176:179], v[192:195]
    v_add_u32 v248, 0x800, v248
    v_add_u32 v249, 0x800, v249
    v_mfma_f32_16x16x32_bf16 v[196:199], v[220:223], v[180:183], v[196:199]
    v_and_or_b32 v248, v248, v15, s80
    v_and_or_b32 v249, v249, v15, s81
    s_nop 2
    v_fmac_f32 v250, v200, v192
    s_nop 1
    v_fmac_f32 v251, v200, v196
    v_fmac_f32 v250, v201, v193
    v_fmac_f32 v251, v201, v197
    v_fmac_f32 v250, v202, v194
    v_fmac_f32 v251, v202, v198
    v_fmac_f32 v250, v203, v195
    v_fmac_f32 v251, v203, v199
    v_add_u32 v250, 0x800, v250
    v_add_u32 v251, 0x800, v251
    v_and_or_b32 v250, v250, v15, s82
    v_and_or_b32 v251, v251, v15, s83
    buffer_store_dwordx4 v[248:251], v13, s[16:19], 0 offen sc1
    s_barrier
    s_endpgm
L_retry2:
    s_add_u32 s89, s89, 1
    s_cmp_lt_u32 s89, 20000
    s_cbranch_scc0 L_got2
    buffer_load_dwordx4 v12, s[16:19], 0 offen offset:0 sc1 lds
    buffer_load_dwordx4 v12, s[16:19], 0 offen offset:1024 sc1 lds
    buffer_load_dwordx4 v12, s[16:19], 0 offen offset:2048 sc1 lds
    buffer_load_dwordx4 v12, s[16:19], 0 offen offset:3072 sc1 lds
    s_waitcnt vmcnt(0)
    s_branch L_chk2
L_retryM:
    s_mov_b64 exec, vcc
    s_add_u32 s89, s89, 1
    s_cmp_lt_u32 s89, 20000
    s_cbranch_scc0 L_gotM
    buffer_load_dwordx4 v[200:203], v9, s[16:19], 0 offen sc1
    s_waitcnt vmcnt(0)
    s_branch L_chkM
L_retry3:
    s_add_u32 s89, s89, 1
    s_cmp_lt_u32 s89, 20000
    s_cbranch_scc0 L_got3
    s_mov_b32 m0, s88
    s_nop 0
    buffer_load_dwordx4 v8, s[16:19], 0 offen offset:0 sc1 lds
    buffer_load_dwordx4 v8, s[16:19], 0 offen offset:1024 sc1 lds
    buffer_load_dwordx4 v8, s[16:19], 0 offen offset:2048 sc1 lds
    buffer_load_dwordx4 v8, s[16:19], 0 offen offset:3072 sc1 lds
    s_waitcnt vmcnt(0)
    s_branch L_chk3
L_end:
    s_endpgm
.section .rodata,"a"
.p2align 6
.amdhsa_kernel gated_mix__compressed_kv_cla__dense_activation_silu__decode_kernel
  .amdhsa_next_free_vgpr 256
  .amdhsa_next_free_sgpr 102
  .amdhsa_accum_offset 256
  .amdhsa_group_segment_fixed_size 0
  .amdhsa_kernarg_size 104
  .amdhsa_user_sgpr_count 2
  .amdhsa_user_sgpr_kernarg_segment_ptr 1
  .amdhsa_system_sgpr_workgroup_id_x 1
.end_amdhsa_kernel
```
